```python
import torch

def _softmax(x, axis=-1):
    return torch.softmax(x, dim=axis)
def _gelu(x):
    return torch.nn.functional.gelu(x, approximate="tanh")
def _silu(x):
    return torch.nn.functional.silu(x)
def _sigmoid(x):
    return torch.sigmoid(x)
def _layernorm(x, axis=-1, eps=1e-5):
    m = x.mean(dim=axis, keepdim=True)
    v = x.var(dim=axis, keepdim=True, unbiased=False)
    return (x - m) / torch.sqrt(v + eps)
def _scatter_add(tgt, idx, src, axis=0):
    return tgt.clone().index_add_(axis, idx, src)
def _segment_sum(src, seg, n):
    out = torch.zeros((n,) + src.shape[1:], dtype=src.dtype)
    return out.index_add_(0, seg, src)
def _pad(x, pw):
    flat = tuple(v for pair in reversed(pw) for v in pair)
    return torch.nn.functional.pad(x, flat)

kernel_name = 'sequential_preLN__mha_block_cached__glu_gated_bilinear__decode'

def setup_inputs():

    _w = (lambda a: (lambda t: t.to(torch.bfloat16) if t.is_floating_point() else t)(torch.as_tensor(a)))
    def _A_setup():
        B, Sq, D = 1, 1, 576
        H, Sk, Dh = 32, 32768, 128
        return {
            "x": _w((lambda *s: torch.randn(*s, dtype=torch.bfloat16) * 0.05)(B, Sq, D)),
            "k_cache": _w((lambda *s: torch.randn(*s, dtype=torch.bfloat16) * 3.2)(B, H, Sk, Dh)),
            "v_cache": _w((lambda *s: torch.randn(*s, dtype=torch.bfloat16) * 1.6)(B, H, Sk, Dh)),
            "wq": _w((lambda *s: torch.randn(*s, dtype=torch.bfloat16) * 3.2)(D, H * Dh) * (D ** -0.5)),
            "wo": _w((lambda *s: torch.randn(*s, dtype=torch.bfloat16) * 1.6)(H * Dh, D) * ((H * Dh) ** -0.5)),
        }
    _A_in = _A_setup()

    def _B_setup():
        B, S, D, F = 1, 1, 576, 4608
        return {
            "x": _w((lambda *s: torch.randn(*s, dtype=torch.bfloat16) * 0.05)(B, S, D)),
            "w_gate": _w((lambda *s: torch.randn(*s, dtype=torch.bfloat16) * 1.6)(D, F) * (D ** -0.5)),
            "w_up": _w((lambda *s: torch.randn(*s, dtype=torch.bfloat16) * 1.6)(D, F) * (D ** -0.5)),
            "w_down": _w((lambda *s: torch.randn(*s, dtype=torch.bfloat16) * 1.6)(F, D) * (F ** -0.5)),
        }
    _B_in = _B_setup()

    return {
        "A_x": _A_in["x"],
        "A_k_cache": _A_in["k_cache"],
        "A_v_cache": _A_in["v_cache"],
        "A_wq": _A_in["wq"],
        "A_wo": _A_in["wo"],
        "B_x": _B_in["x"],
        "B_w_gate": _B_in["w_gate"],
        "B_w_up": _B_in["w_up"],
        "B_w_down": _B_in["w_down"],
    }

def reference(A_x, A_k_cache, A_v_cache, A_wq, A_wo, B_x, B_w_gate, B_w_up, B_w_down):
    def _A_ref(x, k_cache, v_cache, wq, wo):
        B, Sq, D = x.shape
        H, Dh = 32, 128
        q = (lambda x, *d: x.permute(*d))((x @ wq).reshape(B, Sq, H, Dh), 0, 2, 1, 3)
        scores = torch.einsum("bhqd,bhkd->bhqk", q, k_cache) * (Dh ** -0.5)
        p = _softmax(scores, axis=-1)
        o = torch.einsum("bhqk,bhkd->bhqd", p, v_cache)
        return (lambda x, *d: x.permute(*d))(o, 0, 2, 1, 3).reshape(B, Sq, H * Dh) @ wo

    def _B_ref(x, w_gate, w_up, w_down):
        g = torch.einsum("bsd,df->bsf", x, w_gate)
        u = torch.einsum("bsd,df->bsf", x, w_up)
        h = g * u
        return torch.einsum("bsf,fd->bsd", h, w_down)

    x = A_x
    h = x + _A_ref(_layernorm(x, axis=-1), A_k_cache, A_v_cache, A_wq, A_wo)
    h2 = h + _B_ref(_layernorm(h, axis=-1), B_w_gate, B_w_up, B_w_down)
    return h2
```

```asm
; @launch grid=(256,1,1) block=(256,1,1) lds=63232
.amdgcn_target "amdgcn-amd-amdhsa--gfx950"
.text
.globl sequential_preLN__mha_block_cached__glu_gated_bilinear__decode_kernel
.p2align 8
.type sequential_preLN__mha_block_cached__glu_gated_bilinear__decode_kernel,@function
sequential_preLN__mha_block_cached__glu_gated_bilinear__decode_kernel:
    s_cmp_ge_u32 s2, 256
    s_cbranch_scc1 Lend
    s_load_dwordx16 s[4:19], s[0:1], 0
    s_load_dwordx8 s[20:27], s[0:1], 64
    s_mov_b32 s60, s2
    s_lshr_b32 s61, s2, 3
    s_and_b32 s62, s2, 7
    v_lshrrev_b32 v10, 6, v0
    v_and_b32 v1, 63, v0
    v_readfirstlane_b32 s63, v10
    v_lshlrev_b32 v10, 1, v1
    v_lshrrev_b32 v11, 4, v1
    v_and_b32 v12, 15, v1
    v_mov_b32 v14, 0x7ffffff0
    v_mov_b32 v28, -1
    v_mov_b32 v29, -1
    v_mov_b32 v30, -1
    v_mov_b32 v31, -1
    s_mul_i32 s69, s61, 4352
    s_add_u32 s69, s69, 626688
    v_mov_b32 v119, s69
    v_cmp_eq_u32 vcc, 0, v1
    s_lshl_b32 s69, s61, 12
    s_add_u32 s69, s69, 495616
    v_cndmask_b32 v119, v14, v119, vcc
    v_lshl_add_u32 v18, v1, 4, s69
    s_or_b32 s68, s62, s63
    s_mul_i32 s69, s62, 72
    s_mul_i32 s70, s63, 18
    s_add_u32 s69, s69, s70
    v_add_u32 v17, s69, v11
    s_lshl_b32 s70, s61, 8
    v_lshl_add_u32 v13, v17, 13, s70
    v_lshl_add_u32 v13, v12, 4, v13
    v_cmp_le_u32 vcc, 32, v1
    v_lshlrev_b32 v17, 2, v17
    s_mov_b32 s76, 0xffff0000
    v_cndmask_b32 v15, v13, v14, vcc
    s_waitcnt lgkmcnt(0)
    s_mov_b32 s40, s26
    s_and_b32 s41, s27, 0xffff
    s_mov_b32 s42, 765952
    s_mov_b32 s43, 0x20000
    s_cmp_lg_u32 s68, 0
    s_cbranch_scc1 Lnl
    buffer_store_dwordx4 v[28:31], v18, s[40:43], 0 offen offset:0 sc1
    buffer_store_dwordx4 v[28:31], v18, s[40:43], 0 offen offset:1024 sc1
    buffer_store_dwordx4 v[28:31], v18, s[40:43], 0 offen offset:2048 sc1
    buffer_store_dwordx4 v[28:31], v18, s[40:43], 0 offen offset:3072 sc1
    v_mov_b32 v118, 32
    buffer_store_dword v118, v119, s[40:43], 0 offen sc1
Lnl:
    s_mov_b32 s44, s4
    s_and_b32 s45, s5, 0xffff
    s_mov_b32 s46, 1152
    s_mov_b32 s47, 0x20000
    buffer_load_ushort v56, v10, s[44:47], 0 offen offset:0
    buffer_load_ushort v57, v10, s[44:47], 0 offen offset:128
    buffer_load_ushort v58, v10, s[44:47], 0 offen offset:256
    buffer_load_ushort v59, v10, s[44:47], 0 offen offset:384
    buffer_load_ushort v60, v10, s[44:47], 0 offen offset:512
    buffer_load_ushort v61, v10, s[44:47], 0 offen offset:640
    buffer_load_ushort v62, v10, s[44:47], 0 offen offset:768
    buffer_load_ushort v63, v10, s[44:47], 0 offen offset:896
    buffer_load_ushort v64, v10, s[44:47], 0 offen offset:1024
    s_mov_b32 s36, s10
    s_and_b32 s37, s11, 0xffff
    s_mov_b32 s38, 4718592
    s_mov_b32 s39, 0x20000
    s_mov_b32 s67, 0
    buffer_load_dwordx4 v[96:99], v13, s[36:39], s67 offen nt
    s_mov_b32 s67, 32768
    buffer_load_dwordx4 v[100:103], v13, s[36:39], s67 offen nt
    s_mov_b32 s67, 65536
    buffer_load_dwordx4 v[104:107], v13, s[36:39], s67 offen nt
    s_mov_b32 s67, 98304
    buffer_load_dwordx4 v[108:111], v13, s[36:39], s67 offen nt
    s_mov_b32 s67, 131072
    buffer_load_dwordx4 v[112:115], v15, s[36:39], s67 offen nt
    s_lshl_b32 s69, s61, 23
    s_add_u32 s28, s6, s69
    s_addc_u32 s29, s7, 0
    s_and_b32 s29, s29, 0xffff
    s_mov_b32 s30, 0x800000
    s_mov_b32 s31, 0x20000
    s_add_u32 s32, s8, s69
    s_addc_u32 s33, s9, 0
    s_and_b32 s33, s33, 0xffff
    s_mov_b32 s34, 0x800000
    s_mov_b32 s35, 0x20000
    v_lshlrev_b32 v3, 4, v1
    v_bfe_u32 v2, v1, 2, 2
    v_lshlrev_b32 v2, 8, v2
    v_lshl_add_u32 v2, v11, 6, v2
    v_and_b32 v16, 3, v1
    v_lshl_add_u32 v2, v16, 4, v2
    s_lshl_b32 s69, s62, 2
    s_add_u32 s72, s69, s63
    s_lshl_b32 s67, s72, 12
    s_mov_b32 s66, s62
    s_add_u32 s69, s69, s61
    s_and_b32 s69, s69, 31
    s_mov_b32 s64, 0
    s_mov_b32 s65, s69
    s_cmp_lt_u32 s69, 9
    s_cbranch_scc1 Lrole
    s_mov_b32 s64, 1
    s_mul_i32 s65, s66, 18
    s_add_u32 s65, s65, s69
    s_sub_u32 s65, s65, 9
    s_cmp_lt_u32 s69, 27
    s_cbranch_scc1 Lrole
    s_lshl_b32 s65, s69, 3
    s_add_u32 s65, s65, s66
    s_sub_u32 s65, s65, 216
    s_cmp_lt_u32 s65, 36
    s_cselect_b32 s64, 2, 3
Lrole:
    s_lshl_b32 s70, s60, 9
    v_lshl_add_u32 v6, v1, 4, s70
    s_lshl_b32 s70, s60, 4
    s_add_u32 s70, s70, 131072
    v_mov_b32 v13, s70
    v_cndmask_b32 v6, v6, v13, vcc
    v_cmp_lt_u32 vcc, 32, v1
    v_mov_b32 v7, v14
    s_nop 0
    v_cndmask_b32 v6, v6, v14, vcc
    s_cmp_eq_u32 s64, 1
    s_cbranch_scc1 LprF
    s_cmp_lg_u32 s64, 0
    s_cbranch_scc1 Lpr
    s_mul_i32 s69, s66, 2304
    s_lshl_b32 s70, s65, 8
    s_add_u32 s69, s69, s70
    s_add_u32 s69, s69, 135168
    v_lshl_add_u32 v7, v1, 4, s69
    v_cmp_le_u32 vcc, 16, v1
    s_branch Lpr2
LprF:
    s_mul_i32 s69, s63, 9*9216
    s_lshl_b32 s70, s65, 6
    s_add_u32 s69, s69, s70
    s_add_u32 s69, s69, 163840
    v_lshrrev_b32 v7, 2, v1
    v_mul_u32_u24 v7, 9216, v7
    v_lshl_add_u32 v7, v16, 4, v7
    v_add_u32 v7, s69, v7
    v_cmp_le_u32 vcc, 36, v1
Lpr2:
    s_nop 1
    v_cndmask_b32 v7, v7, v14, vcc
Lpr:
    s_mov_b32 s56, s24
    s_and_b32 s57, s25, 0xffff
    s_mov_b32 s58, 256
    s_mov_b32 s59, 0x20000
    s_lshl_b32 s69, s61, 2
    v_mov_b32 v16, s69
    s_mov_b32 s77, 0x3db504f3
    s_mov_b32 s78, 0x3fb8aa3b
    s_mov_b32 s71, 300000
    v_and_b32 v14, 7, v1
    v_cmp_eq_u32 vcc, 0, v14
    v_mov_b32 v15, 0xffff
    s_nop 0
    v_cndmask_b32 v20, 0, v15, vcc
    v_cmp_eq_u32 vcc, 1, v14
    v_mov_b32 v15, s76
    s_nop 0
    v_cndmask_b32 v20, v20, v15, vcc
    v_cmp_eq_u32 vcc, 2, v14
    v_mov_b32 v15, 0xffff
    s_nop 0
    v_cndmask_b32 v21, 0, v15, vcc
    v_cmp_eq_u32 vcc, 3, v14
    v_mov_b32 v15, s76
    s_nop 0
    v_cndmask_b32 v21, v21, v15, vcc
    v_cmp_eq_u32 vcc, 4, v14
    v_mov_b32 v15, 0xffff
    s_nop 0
    v_cndmask_b32 v22, 0, v15, vcc
    v_cmp_eq_u32 vcc, 5, v14
    v_mov_b32 v15, s76
    s_nop 0
    v_cndmask_b32 v22, v22, v15, vcc
    v_cmp_eq_u32 vcc, 6, v14
    v_mov_b32 v15, 0xffff
    s_nop 0
    v_cndmask_b32 v23, 0, v15, vcc
    v_cmp_eq_u32 vcc, 7, v14
    v_mov_b32 v15, s76
    s_nop 0
    v_cndmask_b32 v23, v23, v15, vcc
    v_lshlrev_b32 v14, 2, v14
    v_lshl_add_u32 v14, v11, 7, v14
    s_lshl_b32 s69, s63, 9
    v_add_u32 v19, s69, v14
    s_waitcnt vmcnt(5)
    s_cmp_lg_u32 s68, 0
    s_cbranch_scc1 Lnl2
    v_mov_b32 v118, 1
    s_bfm_b64 exec, 1, 0
    buffer_store_dword v118, v16, s[56:59], 0 offen sc1
    s_mov_b64 exec, -1
Lnl2:
    v_lshlrev_b32 v56, 16, v56
    v_lshlrev_b32 v57, 16, v57
    v_lshlrev_b32 v58, 16, v58
    v_lshlrev_b32 v59, 16, v59
    v_lshlrev_b32 v60, 16, v60
    v_lshlrev_b32 v61, 16, v61
    v_lshlrev_b32 v62, 16, v62
    v_lshlrev_b32 v63, 16, v63
    v_lshlrev_b32 v64, 16, v64
    v_add_f32 v10, v56, v57
    v_add_f32 v10, v10, v58
    v_add_f32 v10, v10, v59
    v_add_f32 v10, v10, v60
    v_add_f32 v10, v10, v61
    v_add_f32 v10, v10, v62
    v_add_f32 v10, v10, v63
    v_add_f32 v10, v10, v64
    s_nop 1
    v_add_f32_dpp v10, v10, v10 row_ror:1 row_mask:0xf bank_mask:0xf
    s_nop 1
    v_add_f32_dpp v10, v10, v10 row_ror:2 row_mask:0xf bank_mask:0xf
    s_nop 1
    v_add_f32_dpp v10, v10, v10 row_ror:4 row_mask:0xf bank_mask:0xf
    s_nop 1
    v_add_f32_dpp v10, v10, v10 row_ror:8 row_mask:0xf bank_mask:0xf
    v_mov_b32 v11, v10
    s_nop 1
    v_permlane16_swap_b32 v10, v11
    s_nop 0
    v_add_f32 v10, v10, v11
    v_mov_b32 v11, v10
    s_nop 1
    v_permlane32_swap_b32 v10, v11
    s_nop 0
    v_add_f32 v10, v10, v11
    v_mul_f32 v12, 0x3ae38e39, v10
    v_mov_b32 v10, 0
    v_sub_f32 v11, v56, v12
    v_fmac_f32 v10, v11, v11
    v_sub_f32 v11, v57, v12
    v_fmac_f32 v10, v11, v11
    v_sub_f32 v11, v58, v12
    v_fmac_f32 v10, v11, v11
    v_sub_f32 v11, v59, v12
    v_fmac_f32 v10, v11, v11
    v_sub_f32 v11, v60, v12
    v_fmac_f32 v10, v11, v11
    v_sub_f32 v11, v61, v12
    v_fmac_f32 v10, v11, v11
    v_sub_f32 v11, v62, v12
    v_fmac_f32 v10, v11, v11
    v_sub_f32 v11, v63, v12
    v_fmac_f32 v10, v11, v11
    v_sub_f32 v11, v64, v12
    v_fmac_f32 v10, v11, v11
    s_nop 1
    v_add_f32_dpp v10, v10, v10 row_ror:1 row_mask:0xf bank_mask:0xf
    s_nop 1
    v_add_f32_dpp v10, v10, v10 row_ror:2 row_mask:0xf bank_mask:0xf
    s_nop 1
    v_add_f32_dpp v10, v10, v10 row_ror:4 row_mask:0xf bank_mask:0xf
    s_nop 1
    v_add_f32_dpp v10, v10, v10 row_ror:8 row_mask:0xf bank_mask:0xf
    v_mov_b32 v11, v10
    s_nop 1
    v_permlane16_swap_b32 v10, v11
    s_nop 0
    v_add_f32 v10, v10, v11
    v_mov_b32 v11, v10
    s_nop 1
    v_permlane32_swap_b32 v10, v11
    s_nop 0
    v_add_f32 v10, v10, v11
    v_mul_f32 v10, 0x3ae38e39, v10
    v_cvt_pk_bf16_f32 v10, v10, v10
    v_and_b32 v10, s76, v10
    v_add_f32 v10, 0x3727c5ac, v10
    v_cvt_pk_bf16_f32 v10, v10, v10
    v_and_b32 v10, s76, v10
    v_sqrt_f32 v10, v10
    v_cvt_pk_bf16_f32 v12, v12, v12
    v_and_b32 v12, s76, v12
    v_cvt_pk_bf16_f32 v10, v10, v10
    v_and_b32 v10, s76, v10
    v_rcp_f32 v11, v10
    v_lshlrev_b32 v13, 2, v1
    v_sub_f32 v56, v56, v12
    v_cvt_pk_bf16_f32 v56, v56, v56
    v_and_b32 v56, s76, v56
    v_mul_f32 v14, v56, v11
    v_fma_f32 v56, -v14, v10, v56
    v_fmac_f32 v14, v56, v11
    v_cvt_pk_bf16_f32 v56, v14, v14
    ds_write_b32 v13, v56 offset:0
    v_sub_f32 v57, v57, v12
    v_cvt_pk_bf16_f32 v57, v57, v57
    v_and_b32 v57, s76, v57
    v_mul_f32 v15, v57, v11
    v_fma_f32 v57, -v15, v10, v57
    v_fmac_f32 v15, v57, v11
    v_cvt_pk_bf16_f32 v57, v15, v15
    ds_write_b32 v13, v57 offset:256
    v_sub_f32 v58, v58, v12
    v_cvt_pk_bf16_f32 v58, v58, v58
    v_and_b32 v58, s76, v58
    v_mul_f32 v14, v58, v11
    v_fma_f32 v58, -v14, v10, v58
    v_fmac_f32 v14, v58, v11
    v_cvt_pk_bf16_f32 v58, v14, v14
    ds_write_b32 v13, v58 offset:512
    v_sub_f32 v59, v59, v12
    v_cvt_pk_bf16_f32 v59, v59, v59
    v_and_b32 v59, s76, v59
    v_mul_f32 v15, v59, v11
    v_fma_f32 v59, -v15, v10, v59
    v_fmac_f32 v15, v59, v11
    v_cvt_pk_bf16_f32 v59, v15, v15
    ds_write_b32 v13, v59 offset:768
    v_sub_f32 v60, v60, v12
    v_cvt_pk_bf16_f32 v60, v60, v60
    v_and_b32 v60, s76, v60
    v_mul_f32 v14, v60, v11
    v_fma_f32 v60, -v14, v10, v60
    v_fmac_f32 v14, v60, v11
    v_cvt_pk_bf16_f32 v60, v14, v14
    ds_write_b32 v13, v60 offset:1024
    v_sub_f32 v61, v61, v12
    v_cvt_pk_bf16_f32 v61, v61, v61
    v_and_b32 v61, s76, v61
    v_mul_f32 v15, v61, v11
    v_fma_f32 v61, -v15, v10, v61
    v_fmac_f32 v15, v61, v11
    v_cvt_pk_bf16_f32 v61, v15, v15
    ds_write_b32 v13, v61 offset:1280
    v_sub_f32 v62, v62, v12
    v_cvt_pk_bf16_f32 v62, v62, v62
    v_and_b32 v62, s76, v62
    v_mul_f32 v14, v62, v11
    v_fma_f32 v62, -v14, v10, v62
    v_fmac_f32 v14, v62, v11
    v_cvt_pk_bf16_f32 v62, v14, v14
    ds_write_b32 v13, v62 offset:1536
    v_sub_f32 v63, v63, v12
    v_cvt_pk_bf16_f32 v63, v63, v63
    v_and_b32 v63, s76, v63
    v_mul_f32 v15, v63, v11
    v_fma_f32 v63, -v15, v10, v63
    v_fmac_f32 v15, v63, v11
    v_cvt_pk_bf16_f32 v63, v15, v15
    ds_write_b32 v13, v63 offset:1792
    v_sub_f32 v64, v64, v12
    v_cvt_pk_bf16_f32 v64, v64, v64
    v_and_b32 v64, s76, v64
    v_mul_f32 v14, v64, v11
    v_fma_f32 v64, -v14, v10, v64
    v_fmac_f32 v14, v64, v11
    v_cvt_pk_bf16_f32 v64, v14, v14
    ds_write_b32 v13, v64 offset:2048
    v_cmp_gt_u32 vcc, 32, v1
    s_waitcnt lgkmcnt(0)
    ds_read_b32 v56, v17 offset:0
    ds_read_b32 v57, v17 offset:16
    ds_read_b32 v58, v17 offset:32
    ds_read_b32 v59, v17 offset:48
    ds_read_b32 v60, v17 offset:64
    s_cmp_lg_u32 s63, 0
    s_cbranch_scc1 Lnp
    buffer_load_dword v118, v16, s[56:59], 0 offen sc1
Lnp:
    buffer_load_dwordx4 v[160:163], v2, s[28:31], s67 offen offset:0 nt
    buffer_load_dwordx4 v[164:167], v2, s[28:31], s67 offen offset:1024 nt
    buffer_load_dwordx4 v[168:171], v2, s[28:31], s67 offen offset:2048 nt
    buffer_load_dwordx4 v[172:175], v2, s[28:31], s67 offen offset:3072 nt
    buffer_load_dwordx4 v[176:179], v3, s[32:35], s67 offen offset:0 nt
    buffer_load_dwordx4 v[180:183], v3, s[32:35], s67 offen offset:1024 nt
    buffer_load_dwordx4 v[184:187], v3, s[32:35], s67 offen offset:2048 nt
    buffer_load_dwordx4 v[188:191], v3, s[32:35], s67 offen offset:3072 nt
    s_add_u32 s67, s67, 32*4096
    s_and_b32 s67, s67, 0x7fffff
    s_cmp_lg_u32 s63, 0
    s_cbranch_scc1 Lnp1
    s_waitcnt vmcnt(9)
    s_branch Lnp2
Lnp1:
    s_waitcnt vmcnt(8)
Lnp2:
    s_waitcnt lgkmcnt(0)
    v_cndmask_b32 v60, 0, v60, vcc
    v_and_b32 v32, v56, v20
    v_and_b32 v33, v56, v21
    v_and_b32 v34, v56, v22
    v_and_b32 v35, v56, v23
    v_and_b32 v36, v57, v20
    v_and_b32 v37, v57, v21
    v_and_b32 v38, v57, v22
    v_and_b32 v39, v57, v23
    v_mfma_f32_16x16x32_bf16 v[24:27], v[96:99], v[32:35], 0
    v_and_b32 v32, v58, v20
    v_and_b32 v33, v58, v21
    v_and_b32 v34, v58, v22
    v_and_b32 v35, v58, v23
    v_mfma_f32_16x16x32_bf16 v[24:27], v[100:103], v[36:39], v[24:27]
    v_and_b32 v36, v59, v20
    v_and_b32 v37, v59, v21
    v_and_b32 v38, v59, v22
    v_and_b32 v39, v59, v23
    v_mfma_f32_16x16x32_bf16 v[24:27], v[104:107], v[32:35], v[24:27]
    v_and_b32 v32, v60, v20
    v_and_b32 v33, v60, v21
    v_and_b32 v34, v60, v22
    v_and_b32 v35, v60, v23
    v_mfma_f32_16x16x32_bf16 v[24:27], v[108:111], v[36:39], v[24:27]
    s_nop 1
    v_mfma_f32_16x16x32_bf16 v[24:27], v[112:115], v[32:35], v[24:27]
    v_and_b32 v11, 31, v1
    v_lshlrev_b32 v11, 4, v11
    s_nop 5
    ds_write_b32 v19, v24 offset:2304
    ds_write_b32 v19, v25 offset:2336
    ds_write_b32 v19, v26 offset:2368
    ds_write_b32 v19, v27 offset:2400
    s_mov_b64 vcc, 0
    s_waitcnt lgkmcnt(0)
    s_barrier
    s_cmp_lg_u32 s63, 0
    s_cbranch_scc1 Lq2
    ds_read_b128 v[56:59], v11 offset:2304
    ds_read_b128 v[60:63], v11 offset:2816
    ds_read_b128 v[64:67], v11 offset:3328
    ds_read_b128 v[68:71], v11 offset:3840
    s_waitcnt lgkmcnt(0)
    v_add_f32 v56, v56, v60
    v_add_f32 v64, v64, v68
    v_add_f32 v72, v56, v64
    v_add_f32 v57, v57, v61
    v_add_f32 v65, v65, v69
    v_add_f32 v73, v57, v65
    v_add_f32 v58, v58, v62
    v_add_f32 v66, v66, v70
    v_add_f32 v74, v58, v66
    v_add_f32 v59, v59, v63
    v_add_f32 v67, v67, v71
    v_add_f32 v75, v59, v67
    v_min_u32 v72, -2, v72
    v_min_u32 v73, -2, v73
    v_min_u32 v74, -2, v74
    v_min_u32 v75, -2, v75
    s_waitcnt vmcnt(8)
Lq0:
    v_cmp_ne_u32 vcc, 1, v118
    s_nop 0
    s_cbranch_vccz Lq1
    buffer_load_dword v118, v16, s[56:59], 0 offen sc1
    s_sub_u32 s71, s71, 1
    s_cbranch_scc1 Lend
    s_waitcnt vmcnt(0)
    s_branch Lq0
Lq1:
    s_lshl_b32 s69, s62, 9
    s_mov_b64 exec, 0xffffffff
    buffer_store_dwordx4 v[72:75], v18, s[40:43], s69 offen sc1
    s_mov_b64 exec, -1
    buffer_store_dwordx4 v[28:31], v6, s[40:43], 0 offen sc1
    s_cmp_eq_u32 s64, 1
    s_cselect_b32 s70, 9*9216, 0
    s_mov_b32 s69, 0
    buffer_store_dwordx4 v[28:31], v7, s[40:43], s69 offen sc1
    s_add_u32 s69, s69, s70
    buffer_store_dwordx4 v[28:31], v7, s[40:43], s69 offen sc1
    s_add_u32 s69, s69, s70
    buffer_store_dwordx4 v[28:31], v7, s[40:43], s69 offen sc1
    s_add_u32 s69, s69, s70
    buffer_store_dwordx4 v[28:31], v7, s[40:43], s69 offen sc1
    s_mov_b64 vcc, -1
Lq2:
    v_lshrrev_b32 v12, 3, v1
    v_and_b32 v13, 7, v1
    s_cmp_eq_u32 s64, 1
    s_cbranch_scc1 LwF
    s_cmp_lg_u32 s64, 0
    s_cbranch_scc1 Lq5
    s_mov_b32 s36, s12
    s_and_b32 s37, s13, 0xffff
    s_mov_b32 s38, 4718592
    s_mov_b32 s39, 0x20000
    s_lshl_b32 s69, s63, 3
    s_add_u32 s69, s69, s66
    s_mul_i32 s69, s69, 128*1152
    s_lshl_b32 s70, s65, 7
    s_add_u32 s69, s69, s70
    v_mul_u32_u24 v8, 4608, v12
    v_lshl_add_u32 v8, v13, 4, v8
    v_add_u32 v8, s69, v8
    s_cbranch_vccz Lg0
    buffer_load_dwordx4 v[56:59], v18, s[40:43], 0 offen offset:0 sc1
    buffer_load_dwordx4 v[60:63], v18, s[40:43], 0 offen offset:1024 sc1
    buffer_load_dwordx4 v[64:67], v18, s[40:43], 0 offen offset:2048 sc1
    buffer_load_dwordx4 v[68:71], v18, s[40:43], 0 offen offset:3072 sc1
Lg0:
    s_mov_b32 s69, 0
    buffer_load_dwordx4 a[0:3], v8, s[36:39], s69 offen offset:0 nt
    s_mov_b32 s69, 0
    buffer_load_dwordx4 a[4:7], v8, s[36:39], s69 offen offset:1152 nt
    s_mov_b32 s69, 0
    buffer_load_dwordx4 a[8:11], v8, s[36:39], s69 offen offset:2304 nt
    s_mov_b32 s69, 0
    buffer_load_dwordx4 a[12:15], v8, s[36:39], s69 offen offset:3456 nt
    s_mov_b32 s69, 36864
    buffer_load_dwordx4 a[16:19], v8, s[36:39], s69 offen offset:0 nt
    s_mov_b32 s69, 36864
    buffer_load_dwordx4 a[20:23], v8, s[36:39], s69 offen offset:1152 nt
    s_mov_b32 s69, 36864
    buffer_load_dwordx4 a[24:27], v8, s[36:39], s69 offen offset:2304 nt
    s_mov_b32 s69, 36864
    buffer_load_dwordx4 a[28:31], v8, s[36:39], s69 offen offset:3456 nt
    s_waitcnt vmcnt(8)
    s_cbranch_vccz Lh0
    v_max_u32 v10, v56, v57
    v_max3_u32 v10, v10, v58, v59
    v_max3_u32 v10, v10, v60, v61
    v_max3_u32 v10, v10, v62, v63
    v_max3_u32 v10, v10, v64, v65
    v_max3_u32 v10, v10, v66, v67
    v_max3_u32 v10, v10, v68, v69
    v_max3_u32 v10, v10, v70, v71
    v_cmp_eq_u32 vcc, -1, v10
    s_nop 0
Lh0:
    s_cbranch_vccz Lg1
    buffer_load_dwordx4 v[56:59], v18, s[40:43], 0 offen offset:0 sc1
    buffer_load_dwordx4 v[60:63], v18, s[40:43], 0 offen offset:1024 sc1
    buffer_load_dwordx4 v[64:67], v18, s[40:43], 0 offen offset:2048 sc1
    buffer_load_dwordx4 v[68:71], v18, s[40:43], 0 offen offset:3072 sc1
Lg1:
    s_mov_b32 s69, 73728
    buffer_load_dwordx4 a[32:35], v8, s[36:39], s69 offen offset:0 nt
    s_mov_b32 s69, 73728
    buffer_load_dwordx4 a[36:39], v8, s[36:39], s69 offen offset:1152 nt
    s_mov_b32 s69, 73728
    buffer_load_dwordx4 a[40:43], v8, s[36:39], s69 offen offset:2304 nt
    s_mov_b32 s69, 73728
    buffer_load_dwordx4 a[44:47], v8, s[36:39], s69 offen offset:3456 nt
    s_mov_b32 s69, 110592
    buffer_load_dwordx4 a[48:51], v8, s[36:39], s69 offen offset:0 nt
    s_mov_b32 s69, 110592
    buffer_load_dwordx4 a[52:55], v8, s[36:39], s69 offen offset:1152 nt
    s_mov_b32 s69, 110592
    buffer_load_dwordx4 a[56:59], v8, s[36:39], s69 offen offset:2304 nt
    s_mov_b32 s69, 110592
    buffer_load_dwordx4 a[60:63], v8, s[36:39], s69 offen offset:3456 nt
    s_waitcnt vmcnt(8)
    s_cbranch_vccz Lh1
    v_max_u32 v10, v56, v57
    v_max3_u32 v10, v10, v58, v59
    v_max3_u32 v10, v10, v60, v61
    v_max3_u32 v10, v10, v62, v63
    v_max3_u32 v10, v10, v64, v65
    v_max3_u32 v10, v10, v66, v67
    v_max3_u32 v10, v10, v68, v69
    v_max3_u32 v10, v10, v70, v71
    v_cmp_eq_u32 vcc, -1, v10
    s_nop 0
Lh1:
    s_branch Lq5
LwF:
    s_mov_b32 s36, s20
    s_and_b32 s37, s21, 0xffff
    s_mov_b32 s38, 5308416
    s_mov_b32 s39, 0x20000
    s_mul_i32 s69, s63, 144*9216
    s_lshl_b32 s70, s65, 6
    s_add_u32 s69, s69, s70
    v_mul_u32_u24 v14, 18432, v12
    v_and_b32 v15, 3, v1
    v_lshl_add_u32 v14, v15, 4, v14
    v_add_u32 v14, s69, v14
    v_cmp_le_u32 s[74:75], 4, v13
    v_mov_b32 v15, s18
    v_mov_b32 v17, s19
    v_mov_b32 v8, s16
    v_mov_b32 v9, s17
    v_cndmask_b32 v8, v8, v15, s[74:75]
    v_cndmask_b32 v9, v9, v17, s[74:75]
    v_add_co_u32 v8, s[74:75], v8, v14
    s_nop 1
    v_addc_co_u32 v9, s[74:75], 0, v9, s[74:75]
    s_lshl_b32 s69, s65, 2
    s_add_u32 s69, s69, s63
    s_mul_i32 s69, s69, 8*1152
    v_mul_u32_u24 v117, 1152, v12
    v_lshl_add_u32 v117, v13, 4, v117
    v_add_u32 v117, s69, v117
    s_mov_b32 s69, 9216
    s_mov_b32 s70, 15*9216
    s_cbranch_vccz Lg2
    buffer_load_dwordx4 v[56:59], v18, s[40:43], 0 offen offset:0 sc1
    buffer_load_dwordx4 v[60:63], v18, s[40:43], 0 offen offset:1024 sc1
    buffer_load_dwordx4 v[64:67], v18, s[40:43], 0 offen offset:2048 sc1
    buffer_load_dwordx4 v[68:71], v18, s[40:43], 0 offen offset:3072 sc1
Lg2:
    global_load_dwordx4 a[0:3], v[8:9], off nt
    v_add_co_u32 v8, s[74:75], s69, v8
    s_nop 1
    v_addc_co_u32 v9, s[74:75], 0, v9, s[74:75]
    global_load_dwordx4 a[4:7], v[8:9], off nt
    v_add_co_u32 v8, s[74:75], s70, v8
    s_nop 1
    v_addc_co_u32 v9, s[74:75], 0, v9, s[74:75]
    global_load_dwordx4 a[8:11], v[8:9], off nt
    v_add_co_u32 v8, s[74:75], s69, v8
    s_nop 1
    v_addc_co_u32 v9, s[74:75], 0, v9, s[74:75]
    global_load_dwordx4 a[12:15], v[8:9], off nt
    v_add_co_u32 v8, s[74:75], s70, v8
    s_nop 1
    v_addc_co_u32 v9, s[74:75], 0, v9, s[74:75]
    global_load_dwordx4 a[16:19], v[8:9], off nt
    v_add_co_u32 v8, s[74:75], s69, v8
    s_nop 1
    v_addc_co_u32 v9, s[74:75], 0, v9, s[74:75]
    global_load_dwordx4 a[20:23], v[8:9], off nt
    v_add_co_u32 v8, s[74:75], s70, v8
    s_nop 1
    v_addc_co_u32 v9, s[74:75], 0, v9, s[74:75]
    s_waitcnt vmcnt(6)
    s_cbranch_vccz Lh2
    v_max_u32 v10, v56, v57
    v_max3_u32 v10, v10, v58, v59
    v_max3_u32 v10, v10, v60, v61
    v_max3_u32 v10, v10, v62, v63
    v_max3_u32 v10, v10, v64, v65
    v_max3_u32 v10, v10, v66, v67
    v_max3_u32 v10, v10, v68, v69
    v_max3_u32 v10, v10, v70, v71
    v_cmp_eq_u32 vcc, -1, v10
    s_nop 0
Lh2:
Lq5:
    s_cbranch_vccz Lg3
    buffer_load_dwordx4 v[56:59], v18, s[40:43], 0 offen offset:0 sc1
    buffer_load_dwordx4 v[60:63], v18, s[40:43], 0 offen offset:1024 sc1
    buffer_load_dwordx4 v[64:67], v18, s[40:43], 0 offen offset:2048 sc1
    buffer_load_dwordx4 v[68:71], v18, s[40:43], 0 offen offset:3072 sc1
Lg3:
    buffer_load_dwordx4 v[128:131], v2, s[28:31], s67 offen offset:0 nt
    buffer_load_dwordx4 v[132:135], v2, s[28:31], s67 offen offset:1024 nt
    buffer_load_dwordx4 v[136:139], v2, s[28:31], s67 offen offset:2048 nt
    buffer_load_dwordx4 v[140:143], v2, s[28:31], s67 offen offset:3072 nt
    buffer_load_dwordx4 v[144:147], v3, s[32:35], s67 offen offset:0 nt
    s_waitcnt vmcnt(5)
    s_cbranch_vccz Lh3
    v_max_u32 v10, v56, v57
    v_max3_u32 v10, v10, v58, v59
    v_max3_u32 v10, v10, v60, v61
    v_max3_u32 v10, v10, v62, v63
    v_max3_u32 v10, v10, v64, v65
    v_max3_u32 v10, v10, v66, v67
    v_max3_u32 v10, v10, v68, v69
    v_max3_u32 v10, v10, v70, v71
    v_cmp_eq_u32 vcc, -1, v10
    s_nop 0
Lh3:
    s_cmp_lg_u32 s63, 0
    s_cbranch_scc1 Lq7
    s_cbranch_vccz Lq4
LpQ:
    buffer_load_dwordx4 v[56:59], v18, s[40:43], 0 offen offset:0 sc1
    buffer_load_dwordx4 v[60:63], v18, s[40:43], 0 offen offset:1024 sc1
    buffer_load_dwordx4 v[64:67], v18, s[40:43], 0 offen offset:2048 sc1
    buffer_load_dwordx4 v[68:71], v18, s[40:43], 0 offen offset:3072 sc1
    s_sub_u32 s71, s71, 1
    s_cbranch_scc1 Lend
    s_waitcnt vmcnt(0)
    v_max_u32 v10, v56, v57
    v_max3_u32 v10, v10, v58, v59
    v_max3_u32 v10, v10, v60, v61
    v_max3_u32 v10, v10, v62, v63
    v_max3_u32 v10, v10, v64, v65
    v_max3_u32 v10, v10, v66, v67
    v_max3_u32 v10, v10, v68, v69
    v_max3_u32 v10, v10, v70, v71
    v_cmp_eq_u32 vcc, -1, v10
    s_nop 0
    s_cbranch_vccnz LpQ
Lq4:
    s_bfm_b64 exec, 1, 0
    buffer_atomic_add v118, v16, s[56:59], 0 offen offset:128 sc1
    s_mov_b64 exec, -1
    v_add_f32 v56, v56, v60
    v_add_f32 v64, v64, v68
    v_add_f32 v56, v56, v64
    v_add_f32 v57, v57, v61
    v_add_f32 v65, v65, v69
    v_add_f32 v57, v57, v65
    v_add_f32 v58, v58, v62
    v_add_f32 v66, v66, v70
    v_add_f32 v58, v58, v66
    v_add_f32 v59, v59, v63
    v_add_f32 v67, v67, v71
    v_add_f32 v59, v59, v67
    v_mov_b32 v60, v56
    v_mov_b32 v61, v57
    v_mov_b32 v62, v58
    v_mov_b32 v63, v59
    v_permlane32_swap_b32 v56, v60
    v_permlane32_swap_b32 v57, v61
    v_permlane32_swap_b32 v58, v62
    v_permlane32_swap_b32 v59, v63
    v_add_f32 v56, v56, v60
    v_add_f32 v57, v57, v61
    v_add_f32 v58, v58, v62
    v_add_f32 v59, v59, v63
    v_cvt_pk_bf16_f32 v56, v56, v57
    v_cvt_pk_bf16_f32 v57, v58, v59
    v_lshrrev_b32 v11, 1, v11
    ds_write_b64 v11, v[56:57] offset:4352
Lq7:
    v_and_b32 v12, 0xf0, v2
    v_bfe_u32 v14, v1, 2, 2
    s_waitcnt lgkmcnt(0)
    s_barrier
    ds_read_b128 v[64:67], v12 offset:4352
    v_mov_b32 v24, 0
    v_mov_b32 v25, 0
    v_mov_b32 v26, 0
    v_mov_b32 v27, 0
    v_mov_b32 v4, 0xff800000
    v_mov_b32 v5, 0
    s_add_u32 s69, s72, 64
    v_mov_b32 v118, s69
    s_waitcnt lgkmcnt(0)
    v_cmp_eq_u32 vcc, 0, v14
    s_nop 1
    v_cndmask_b32 v40, 0, v64, vcc
    v_cndmask_b32 v41, 0, v65, vcc
    v_cndmask_b32 v42, 0, v66, vcc
    v_cndmask_b32 v43, 0, v67, vcc
    v_cmp_eq_u32 vcc, 1, v14
    s_nop 1
    v_cndmask_b32 v44, 0, v64, vcc
    v_cndmask_b32 v45, 0, v65, vcc
    v_cndmask_b32 v46, 0, v66, vcc
    v_cndmask_b32 v47, 0, v67, vcc
    v_cmp_eq_u32 vcc, 2, v14
    s_nop 1
    v_cndmask_b32 v48, 0, v64, vcc
    v_cndmask_b32 v49, 0, v65, vcc
    v_cndmask_b32 v50, 0, v66, vcc
    v_cndmask_b32 v51, 0, v67, vcc
    v_cmp_eq_u32 vcc, 3, v14
    s_nop 1
    v_cndmask_b32 v52, 0, v64, vcc
    v_cndmask_b32 v53, 0, v65, vcc
    v_cndmask_b32 v54, 0, v66, vcc
    v_cndmask_b32 v55, 0, v67, vcc
    s_waitcnt vmcnt(9)
    v_mfma_f32_16x16x32_bf16 v[28:31], v[160:163], v[40:43], 0
    v_mfma_f32_16x16x32_bf16 v[28:31], v[164:167], v[44:47], v[28:31]
    v_mfma_f32_16x16x32_bf16 v[28:31], v[168:171], v[48:51], v[28:31]
    v_mfma_f32_16x16x32_bf16 v[28:31], v[172:175], v[52:55], v[28:31]
    s_nop 7
    v_mov_b32_dpp v10, v28 quad_perm:[0,0,0,0] row_mask:0xf bank_mask:0xf
    v_mov_b32_dpp v11, v29 quad_perm:[1,1,1,1] row_mask:0xf bank_mask:0xf
    v_mov_b32_dpp v12, v30 quad_perm:[2,2,2,2] row_mask:0xf bank_mask:0xf
    v_mov_b32_dpp v13, v31 quad_perm:[3,3,3,3] row_mask:0xf bank_mask:0xf
    v_add_f32 v10, v10, v11
    v_add_f32 v12, v12, v13
    v_add_f32 v10, v10, v12
    v_cvt_pk_bf16_f32 v10, v10, v10
    v_and_b32 v10, s76, v10
    v_mul_f32 v10, s77, v10
    v_cvt_pk_bf16_f32 v10, v10, v10
    v_and_b32 v10, s76, v10
    v_cmp_gt_f32 vcc, v10, v4
    s_nop 0
    s_cbranch_vccz Lnm1
    v_max_f32 v11, v10, v4
    s_nop 1
    v_max_f32_dpp v11, v11, v11 row_ror:4 row_mask:0xf bank_mask:0xf
    s_nop 1
    v_max_f32_dpp v11, v11, v11 row_ror:8 row_mask:0xf bank_mask:0xf
    v_mov_b32 v12, v11
    s_nop 1
    v_permlane16_swap_b32 v11, v12
    s_nop 0
    v_max_f32 v11, v11, v12
    v_mov_b32 v12, v11
    s_nop 1
    v_permlane32_swap_b32 v11, v12
    s_nop 0
    v_max_f32 v11, v11, v12
    v_sub_f32 v12, v4, v11
    v_mul_f32 v12, s78, v12
    v_exp_f32 v12, v12
    v_mov_b32 v4, v11
    v_mul_f32 v24, v24, v12
    v_mul_f32 v25, v25, v12
    v_mul_f32 v26, v26, v12
    v_mul_f32 v27, v27, v12
    v_mul_f32 v5, v5, v12
Lnm1:
    v_sub_f32 v10, v10, v4
    v_mul_f32 v10, s78, v10
    v_exp_f32 v10, v10
    s_nop 0
    v_cvt_pk_bf16_f32 v11, v10, v10
    v_add_f32 v5, v5, v10
    s_waitcnt vmcnt(5)
    v_and_b32_dpp v32, v11, v20 row_newbcast:0 row_mask:0xf bank_mask:0xf
    v_and_b32_dpp v33, v11, v21 row_newbcast:0 row_mask:0xf bank_mask:0xf
    v_and_b32_dpp v34, v11, v22 row_newbcast:0 row_mask:0xf bank_mask:0xf
    v_and_b32_dpp v35, v11, v23 row_newbcast:0 row_mask:0xf bank_mask:0xf
    s_nop 1
    v_mfma_f32_16x16x32_bf16 v[24:27], v[176:179], v[32:35], v[24:27]
    v_and_b32_dpp v36, v11, v20 row_newbcast:4 row_mask:0xf bank_mask:0xf
    v_and_b32_dpp v37, v11, v21 row_newbcast:4 row_mask:0xf bank_mask:0xf
    v_and_b32_dpp v38, v11, v22 row_newbcast:4 row_mask:0xf bank_mask:0xf
    v_and_b32_dpp v39, v11, v23 row_newbcast:4 row_mask:0xf bank_mask:0xf
    s_nop 1
    v_mfma_f32_16x16x32_bf16 v[24:27], v[180:183], v[36:39], v[24:27]
    v_and_b32_dpp v32, v11, v20 row_newbcast:8 row_mask:0xf bank_mask:0xf
    v_and_b32_dpp v33, v11, v21 row_newbcast:8 row_mask:0xf bank_mask:0xf
    v_and_b32_dpp v34, v11, v22 row_newbcast:8 row_mask:0xf bank_mask:0xf
    v_and_b32_dpp v35, v11, v23 row_newbcast:8 row_mask:0xf bank_mask:0xf
    s_nop 1
    v_mfma_f32_16x16x32_bf16 v[24:27], v[184:187], v[32:35], v[24:27]
    v_and_b32_dpp v36, v11, v20 row_newbcast:12 row_mask:0xf bank_mask:0xf
    v_and_b32_dpp v37, v11, v21 row_newbcast:12 row_mask:0xf bank_mask:0xf
    v_and_b32_dpp v38, v11, v22 row_newbcast:12 row_mask:0xf bank_mask:0xf
    v_and_b32_dpp v39, v11, v23 row_newbcast:12 row_mask:0xf bank_mask:0xf
    s_nop 1
    v_mfma_f32_16x16x32_bf16 v[24:27], v[188:191], v[36:39], v[24:27]
    v_mov_b32 v118, s72
    s_mov_b32 s86, 0
    v_mov_b32 v115, 0x7ffffff0
    s_mov_b64 s[90:91], s[28:29]
    s_mov_b64 s[92:93], s[32:33]
    v_mov_b32 v104, v2
    v_mov_b32 v105, v3
    s_mul_i32 s69, s63, 7680
    v_lshl_add_u32 v106, v1, 2, s69
    v_mov_b32 v109, 0xff800000
    s_mov_b32 s89, 0
.p2align 6
Lloopa:
    s_waitcnt vmcnt(4)
    v_mfma_f32_16x16x32_bf16 v[28:31], v[128:131], v[40:43], 0
    buffer_load_dwordx4 v[148:151], v3, s[32:35], s67 offen offset:1024 nt
Lskipa:
    s_waitcnt vmcnt(4)
    v_mfma_f32_16x16x32_bf16 v[28:31], v[132:135], v[44:47], v[28:31]
    buffer_load_dwordx4 v[152:155], v3, s[32:35], s67 offen offset:2048 nt
    s_waitcnt vmcnt(4)
    v_mfma_f32_16x16x32_bf16 v[28:31], v[136:139], v[48:51], v[28:31]
    buffer_load_dwordx4 v[156:159], v3, s[32:35], s67 offen offset:3072 nt
    s_waitcnt vmcnt(4)
    v_mfma_f32_16x16x32_bf16 v[28:31], v[140:143], v[52:55], v[28:31]
    s_sub_u32 s86, s86, 1
    s_cbranch_scc1 Lnewa
    s_add_u32 s67, s67, 131072
    buffer_load_dword v116, v115, s[40:43], 0 offen
Lfin2a:
    buffer_load_dwordx4 v[128:131], v2, s[28:31], s67 offen offset:0 nt
    s_nop 7
    v_mov_b32_dpp v10, v28 quad_perm:[0,0,0,0] row_mask:0xf bank_mask:0xf
    v_mov_b32_dpp v11, v29 quad_perm:[1,1,1,1] row_mask:0xf bank_mask:0xf
    v_mov_b32_dpp v12, v30 quad_perm:[2,2,2,2] row_mask:0xf bank_mask:0xf
    v_mov_b32_dpp v13, v31 quad_perm:[3,3,3,3] row_mask:0xf bank_mask:0xf
    v_add_f32 v10, v10, v11
    v_add_f32 v12, v12, v13
    v_add_f32 v10, v10, v12
    v_cvt_pk_bf16_f32 v10, v10, v10
    v_and_b32 v10, s76, v10
    v_mul_f32 v10, s77, v10
    v_cvt_pk_bf16_f32 v10, v10, v10
    v_and_b32 v10, s76, v10
    v_cmp_gt_f32 vcc, v10, v4
    s_nop 0
    s_cbranch_vccz Lnm2
    v_max_f32 v11, v10, v4
    s_nop 1
    v_max_f32_dpp v11, v11, v11 row_ror:4 row_mask:0xf bank_mask:0xf
    s_nop 1
    v_max_f32_dpp v11, v11, v11 row_ror:8 row_mask:0xf bank_mask:0xf
    v_mov_b32 v12, v11
    s_nop 1
    v_permlane16_swap_b32 v11, v12
    s_nop 0
    v_max_f32 v11, v11, v12
    v_mov_b32 v12, v11
    s_nop 1
    v_permlane32_swap_b32 v11, v12
    s_nop 0
    v_max_f32 v11, v11, v12
    v_sub_f32 v12, v4, v11
    v_mul_f32 v12, s78, v12
    v_exp_f32 v12, v12
    v_mov_b32 v4, v11
    v_mul_f32 v24, v24, v12
    v_mul_f32 v25, v25, v12
    v_mul_f32 v26, v26, v12
    v_mul_f32 v27, v27, v12
    v_mul_f32 v5, v5, v12
Lnm2:
    v_sub_f32 v10, v10, v4
    v_mul_f32 v10, s78, v10
    v_exp_f32 v10, v10
    s_nop 0
    v_cvt_pk_bf16_f32 v11, v10, v10
    v_add_f32 v5, v5, v10
    s_nop 0
    v_and_b32_dpp v32, v11, v20 row_newbcast:0 row_mask:0xf bank_mask:0xf
    v_and_b32_dpp v33, v11, v21 row_newbcast:0 row_mask:0xf bank_mask:0xf
    v_and_b32_dpp v34, v11, v22 row_newbcast:0 row_mask:0xf bank_mask:0xf
    v_and_b32_dpp v35, v11, v23 row_newbcast:0 row_mask:0xf bank_mask:0xf
    s_waitcnt vmcnt(5)
    s_nop 0
    v_mfma_f32_16x16x32_bf16 v[24:27], v[144:147], v[32:35], v[24:27]
    buffer_load_dwordx4 v[132:135], v2, s[28:31], s67 offen offset:1024 nt
    v_and_b32_dpp v36, v11, v20 row_newbcast:4 row_mask:0xf bank_mask:0xf
    v_and_b32_dpp v37, v11, v21 row_newbcast:4 row_mask:0xf bank_mask:0xf
    v_and_b32_dpp v38, v11, v22 row_newbcast:4 row_mask:0xf bank_mask:0xf
    v_and_b32_dpp v39, v11, v23 row_newbcast:4 row_mask:0xf bank_mask:0xf
    s_waitcnt vmcnt(5)
    s_nop 0
    v_mfma_f32_16x16x32_bf16 v[24:27], v[148:151], v[36:39], v[24:27]
    buffer_load_dwordx4 v[136:139], v2, s[28:31], s67 offen offset:2048 nt
    v_and_b32_dpp v32, v11, v20 row_newbcast:8 row_mask:0xf bank_mask:0xf
    v_and_b32_dpp v33, v11, v21 row_newbcast:8 row_mask:0xf bank_mask:0xf
    v_and_b32_dpp v34, v11, v22 row_newbcast:8 row_mask:0xf bank_mask:0xf
    v_and_b32_dpp v35, v11, v23 row_newbcast:8 row_mask:0xf bank_mask:0xf
    s_waitcnt vmcnt(5)
    s_nop 0
    v_mfma_f32_16x16x32_bf16 v[24:27], v[152:155], v[32:35], v[24:27]
    buffer_load_dwordx4 v[140:143], v2, s[28:31], s67 offen offset:3072 nt
    v_and_b32_dpp v36, v11, v20 row_newbcast:12 row_mask:0xf bank_mask:0xf
    v_and_b32_dpp v37, v11, v21 row_newbcast:12 row_mask:0xf bank_mask:0xf
    v_and_b32_dpp v38, v11, v22 row_newbcast:12 row_mask:0xf bank_mask:0xf
    v_and_b32_dpp v39, v11, v23 row_newbcast:12 row_mask:0xf bank_mask:0xf
    s_waitcnt vmcnt(5)
    s_nop 0
    v_mfma_f32_16x16x32_bf16 v[24:27], v[156:159], v[36:39], v[24:27]
    buffer_load_dwordx4 v[144:147], v3, s[32:35], s67 offen offset:0 nt
    s_cmp_lt_u32 s68, 32
    s_cbranch_scc1 Lloopk
Lbota:
    s_cmp_lt_u32 s68, 32
    s_cbranch_scc1 Lloopa
    s_cmp_lt_u32 s68, 96
    s_cbranch_scc0 Lexita
    buffer_load_dwordx4 v[148:151], v3, s[32:35], s67 offen offset:1024 nt
    s_branch Lloopb
Lnewa:
    v_readfirstlane_b32 s68, v118
    s_cmp_lt_u32 s68, 96
    s_cbranch_scc0 Lfina
    s_cmp_lt_u32 s68, 32
    s_cbranch_scc0 Lat
    buffer_load_dword v116, v115, s[40:43], 0 offen
    s_branch Lat2
Lat:
    v_mov_b32 v118, 1
    buffer_atomic_add v118, v119, s[40:43], 0 offen sc0 sc1
Lat2:
    s_lshr_b32 s69, s68, 5
    s_min_u32 s69, s69, 1
    s_mul_i32 s69, s69, 1888
    s_add_u32 s69, s69, s68
    s_add_u32 s69, s69, 64
    s_lshl_b32 s67, s69, 12
    s_cmp_lt_u32 s68, 32
    s_cselect_b32 s86, 29, 0
    s_cbranch_scc0 Lfin2a
    s_add_u32 s32, s90, 16384
    s_addc_u32 s33, s91, 0
    v_mov_b32 v3, v104
    s_and_b32 s69, s68, 28
    s_lshl_b32 s69, s69, 12
    s_add_u32 s67, s67, s69
    s_branch Lfin2a
Lfina:
    v_and_b32 v14, 31, v1
    v_lshlrev_b32 v14, 2, v14
    buffer_load_dword v120, v14, s[56:59], 0 offen offset:128 sc1
    s_mov_b32 s67, 0x800000
    s_branch Lfin2a
.p2align 6
Lloopk:
    s_waitcnt vmcnt(4)
    v_mfma_f32_16x16x32_bf16 v[28:31], v[128:131], v[40:43], 0
    buffer_load_dwordx4 v[148:151], v3, s[32:35], s67 offen offset:1024 nt
    s_waitcnt vmcnt(4)
    v_mfma_f32_16x16x32_bf16 v[28:31], v[132:135], v[44:47], v[28:31]
    buffer_load_dwordx4 v[152:155], v3, s[32:35], s67 offen offset:2048 nt
    s_waitcnt vmcnt(4)
    v_mfma_f32_16x16x32_bf16 v[28:31], v[136:139], v[48:51], v[28:31]
    buffer_load_dwordx4 v[156:159], v3, s[32:35], s67 offen offset:3072 nt
    s_waitcnt vmcnt(4)
    v_mfma_f32_16x16x32_bf16 v[28:31], v[140:143], v[52:55], v[28:31]
    s_sub_u32 s86, s86, 1
    s_cbranch_scc1 Lnewk
    s_add_u32 s67, s67, 262144
Lfin2k:
    buffer_load_dwordx4 v[128:131], v2, s[28:31], s67 offen offset:0 nt
    s_nop 7
    v_mov_b32_dpp v10, v28 quad_perm:[0,0,0,0] row_mask:0xf bank_mask:0xf
    v_mov_b32_dpp v11, v29 quad_perm:[1,1,1,1] row_mask:0xf bank_mask:0xf
    v_mov_b32_dpp v12, v30 quad_perm:[2,2,2,2] row_mask:0xf bank_mask:0xf
    v_mov_b32_dpp v13, v31 quad_perm:[3,3,3,3] row_mask:0xf bank_mask:0xf
    v_add_f32 v10, v10, v11
    v_add_f32 v12, v12, v13
    v_add_f32 v108, v10, v12
    v_cvt_pk_bf16_f32 v108, v108, v108
    v_and_b32 v108, s76, v108
    v_mul_f32 v108, s77, v108
    v_cvt_pk_bf16_f32 v108, v108, v108
    v_and_b32 v108, s76, v108
    s_waitcnt vmcnt(4)
    v_mfma_f32_16x16x32_bf16 v[28:31], v[144:147], v[40:43], 0
    buffer_load_dwordx4 v[132:135], v2, s[28:31], s67 offen offset:1024 nt
    s_waitcnt vmcnt(4)
    v_mfma_f32_16x16x32_bf16 v[28:31], v[148:151], v[44:47], v[28:31]
    buffer_load_dwordx4 v[136:139], v2, s[28:31], s67 offen offset:2048 nt
    s_waitcnt vmcnt(4)
    v_mfma_f32_16x16x32_bf16 v[28:31], v[152:155], v[48:51], v[28:31]
    buffer_load_dwordx4 v[140:143], v2, s[28:31], s67 offen offset:3072 nt
    s_waitcnt vmcnt(4)
    v_mfma_f32_16x16x32_bf16 v[28:31], v[156:159], v[52:55], v[28:31]
    buffer_load_dwordx4 v[144:147], v3, s[32:35], s67 offen offset:0 nt
    s_nop 7
    v_mov_b32_dpp v10, v28 quad_perm:[0,0,0,0] row_mask:0xf bank_mask:0xf
    v_mov_b32_dpp v11, v29 quad_perm:[1,1,1,1] row_mask:0xf bank_mask:0xf
    v_mov_b32_dpp v12, v30 quad_perm:[2,2,2,2] row_mask:0xf bank_mask:0xf
    v_mov_b32_dpp v13, v31 quad_perm:[3,3,3,3] row_mask:0xf bank_mask:0xf
    v_add_f32 v10, v10, v11
    v_add_f32 v12, v12, v13
    v_add_f32 v10, v10, v12
    v_cvt_pk_bf16_f32 v10, v10, v10
    v_and_b32 v10, s76, v10
    v_mul_f32 v10, s77, v10
    v_cvt_pk_bf16_f32 v10, v10, v10
    v_and_b32 v10, s76, v10
    v_max3_f32 v109, v109, v108, v10
    v_lshrrev_b32 v108, 16, v108
    v_or_b32 v108, v108, v10
    ds_write_b32 v106, v108 offset:32256
    v_add_u32 v106, 256, v106
    s_cmp_eq_u32 s89, 0
    s_cbranch_scc1 Lloopk
    v_subrev_u32 v106, 7680, v106
    ds_read_b32 v107, v106 offset:32256
    v_max_f32 v11, v109, v4
    s_nop 1
    v_max_f32_dpp v11, v11, v11 row_ror:4 row_mask:0xf bank_mask:0xf
    s_nop 1
    v_max_f32_dpp v11, v11, v11 row_ror:8 row_mask:0xf bank_mask:0xf
    v_mov_b32 v12, v11
    s_nop 1
    v_permlane16_swap_b32 v11, v12
    s_nop 0
    v_max_f32 v11, v11, v12
    v_mov_b32 v12, v11
    s_nop 1
    v_permlane32_swap_b32 v11, v12
    s_nop 0
    v_max_f32 v11, v11, v12
    v_sub_f32 v12, v4, v11
    v_mul_f32 v12, s78, v12
    v_exp_f32 v12, v12
    v_mov_b32 v4, v11
    v_mul_f32 v24, v24, v12
    v_mul_f32 v25, v25, v12
    v_mul_f32 v26, v26, v12
    v_mul_f32 v27, v27, v12
    v_mul_f32 v5, v5, v12
Lloopv:
    s_waitcnt lgkmcnt(0)
    v_lshlrev_b32 v10, 16, v107
    v_and_b32 v11, s76, v107
    ds_read_b32 v107, v106 offset:32512
    v_add_u32 v106, 256, v106
    v_sub_f32 v10, v10, v4
    v_sub_f32 v11, v11, v4
    v_mul_f32 v10, s78, v10
    v_mul_f32 v11, s78, v11
    v_exp_f32 v10, v10
    v_exp_f32 v11, v11
    s_nop 0
    v_cvt_pk_bf16_f32 v12, v10, v10
    v_add_f32 v5, v5, v10
    v_cvt_pk_bf16_f32 v13, v11, v11
    v_add_f32 v5, v5, v11
    v_and_b32_dpp v32, v12, v20 row_newbcast:0 row_mask:0xf bank_mask:0xf
    v_and_b32_dpp v33, v12, v21 row_newbcast:0 row_mask:0xf bank_mask:0xf
    v_and_b32_dpp v34, v12, v22 row_newbcast:0 row_mask:0xf bank_mask:0xf
    v_and_b32_dpp v35, v12, v23 row_newbcast:0 row_mask:0xf bank_mask:0xf
    s_waitcnt vmcnt(4)
    s_nop 0
    v_mfma_f32_16x16x32_bf16 v[24:27], v[128:131], v[32:35], v[24:27]
    buffer_load_dwordx4 v[148:151], v3, s[32:35], s67 offen offset:1024 nt
    v_and_b32_dpp v36, v12, v20 row_newbcast:4 row_mask:0xf bank_mask:0xf
    v_and_b32_dpp v37, v12, v21 row_newbcast:4 row_mask:0xf bank_mask:0xf
    v_and_b32_dpp v38, v12, v22 row_newbcast:4 row_mask:0xf bank_mask:0xf
    v_and_b32_dpp v39, v12, v23 row_newbcast:4 row_mask:0xf bank_mask:0xf
    s_waitcnt vmcnt(4)
    s_nop 0
    v_mfma_f32_16x16x32_bf16 v[24:27], v[132:135], v[36:39], v[24:27]
    buffer_load_dwordx4 v[152:155], v3, s[32:35], s67 offen offset:2048 nt
    v_and_b32_dpp v32, v12, v20 row_newbcast:8 row_mask:0xf bank_mask:0xf
    v_and_b32_dpp v33, v12, v21 row_newbcast:8 row_mask:0xf bank_mask:0xf
    v_and_b32_dpp v34, v12, v22 row_newbcast:8 row_mask:0xf bank_mask:0xf
    v_and_b32_dpp v35, v12, v23 row_newbcast:8 row_mask:0xf bank_mask:0xf
    s_waitcnt vmcnt(4)
    s_nop 0
    v_mfma_f32_16x16x32_bf16 v[24:27], v[136:139], v[32:35], v[24:27]
    buffer_load_dwordx4 v[156:159], v3, s[32:35], s67 offen offset:3072 nt
    v_and_b32_dpp v36, v12, v20 row_newbcast:12 row_mask:0xf bank_mask:0xf
    v_and_b32_dpp v37, v12, v21 row_newbcast:12 row_mask:0xf bank_mask:0xf
    v_and_b32_dpp v38, v12, v22 row_newbcast:12 row_mask:0xf bank_mask:0xf
    v_and_b32_dpp v39, v12, v23 row_newbcast:12 row_mask:0xf bank_mask:0xf
    s_waitcnt vmcnt(4)
    s_nop 0
    v_mfma_f32_16x16x32_bf16 v[24:27], v[140:143], v[36:39], v[24:27]
    s_sub_u32 s86, s86, 1
    s_cbranch_scc1 Lnewv
    s_add_u32 s67, s67, 262144
    s_cmp_lg_u32 s86, 0
    s_cbranch_scc1 Lfin2v
    v_mov_b32 v118, 1
    buffer_atomic_add v118, v119, s[40:43], 0 offen sc0 sc1
Lfin2v:
    buffer_load_dwordx4 v[128:131], v2, s[28:31], s67 offen offset:0 nt
    v_and_b32_dpp v32, v13, v20 row_newbcast:0 row_mask:0xf bank_mask:0xf
    v_and_b32_dpp v33, v13, v21 row_newbcast:0 row_mask:0xf bank_mask:0xf
    v_and_b32_dpp v34, v13, v22 row_newbcast:0 row_mask:0xf bank_mask:0xf
    v_and_b32_dpp v35, v13, v23 row_newbcast:0 row_mask:0xf bank_mask:0xf
    s_waitcnt vmcnt(4)
    s_nop 0
    v_mfma_f32_16x16x32_bf16 v[24:27], v[144:147], v[32:35], v[24:27]
    buffer_load_dwordx4 v[132:135], v2, s[28:31], s67 offen offset:1024 nt
    v_and_b32_dpp v36, v13, v20 row_newbcast:4 row_mask:0xf bank_mask:0xf
    v_and_b32_dpp v37, v13, v21 row_newbcast:4 row_mask:0xf bank_mask:0xf
    v_and_b32_dpp v38, v13, v22 row_newbcast:4 row_mask:0xf bank_mask:0xf
    v_and_b32_dpp v39, v13, v23 row_newbcast:4 row_mask:0xf bank_mask:0xf
    s_waitcnt vmcnt(4)
    s_nop 0
    v_mfma_f32_16x16x32_bf16 v[24:27], v[148:151], v[36:39], v[24:27]
    buffer_load_dwordx4 v[136:139], v2, s[28:31], s67 offen offset:2048 nt
    v_and_b32_dpp v32, v13, v20 row_newbcast:8 row_mask:0xf bank_mask:0xf
    v_and_b32_dpp v33, v13, v21 row_newbcast:8 row_mask:0xf bank_mask:0xf
    v_and_b32_dpp v34, v13, v22 row_newbcast:8 row_mask:0xf bank_mask:0xf
    v_and_b32_dpp v35, v13, v23 row_newbcast:8 row_mask:0xf bank_mask:0xf
    s_waitcnt vmcnt(4)
    s_nop 0
    v_mfma_f32_16x16x32_bf16 v[24:27], v[152:155], v[32:35], v[24:27]
    buffer_load_dwordx4 v[140:143], v2, s[28:31], s67 offen offset:3072 nt
    v_and_b32_dpp v36, v13, v20 row_newbcast:12 row_mask:0xf bank_mask:0xf
    v_and_b32_dpp v37, v13, v21 row_newbcast:12 row_mask:0xf bank_mask:0xf
    v_and_b32_dpp v38, v13, v22 row_newbcast:12 row_mask:0xf bank_mask:0xf
    v_and_b32_dpp v39, v13, v23 row_newbcast:12 row_mask:0xf bank_mask:0xf
    s_waitcnt vmcnt(4)
    s_nop 0
    v_mfma_f32_16x16x32_bf16 v[24:27], v[156:159], v[36:39], v[24:27]
    buffer_load_dwordx4 v[144:147], v3, s[32:35], s67 offen offset:0 nt
    s_cmp_lt_u32 s68, 32
    s_cbranch_scc1 Lloopv
    s_branch Lbota
Lnewk:
    s_mov_b64 s[28:29], s[92:93]
    s_add_u32 s32, s92, 16384
    s_addc_u32 s33, s93, 0
    v_mov_b32 v2, v105
    v_mov_b32 v3, v105
    s_sub_u32 s67, s67, 7602176
    s_mov_b32 s86, 29
    s_mov_b32 s89, 1
    s_branch Lfin2k
Lnewv:
    s_mov_b64 s[28:29], s[90:91]
    s_mov_b64 s[32:33], s[92:93]
    v_mov_b32 v2, v104
    v_readfirstlane_b32 s68, v118
    s_cmp_lt_u32 s68, 96
    s_cbranch_scc0 Lfinv
    v_mov_b32 v118, 1
    buffer_atomic_add v118, v119, s[40:43], 0 offen sc0 sc1
    s_lshr_b32 s69, s68, 5
    s_min_u32 s69, s69, 1
    s_mul_i32 s69, s69, 1888
    s_add_u32 s69, s69, s68
    s_add_u32 s69, s69, 64
    s_lshl_b32 s67, s69, 12
    s_cmp_lt_u32 s68, 32
    s_cselect_b32 s86, 29, 0
    s_branch Lfin2v
Lfinv:
    v_and_b32 v14, 31, v1
    v_lshlrev_b32 v14, 2, v14
    buffer_load_dword v120, v14, s[56:59], 0 offen offset:128 sc1
    s_mov_b32 s67, 0x800000
    s_branch Lfin2v
.p2align 6
Lloopb:
    s_waitcnt vmcnt(5)
    v_mfma_f32_16x16x32_bf16 v[28:31], v[128:131], v[40:43], 0
    buffer_load_dwordx4 v[152:155], v3, s[32:35], s67 offen offset:2048 nt
Lskipb:
    s_waitcnt vmcnt(5)
    v_mfma_f32_16x16x32_bf16 v[28:31], v[132:135], v[44:47], v[28:31]
    buffer_load_dwordx4 v[156:159], v3, s[32:35], s67 offen offset:3072 nt
    s_waitcnt vmcnt(5)
    v_mfma_f32_16x16x32_bf16 v[28:31], v[136:139], v[48:51], v[28:31]
    s_sub_u32 s86, s86, 1
    s_cbranch_scc1 Lnewb
    s_add_u32 s67, s67, 131072
    buffer_load_dword v116, v115, s[40:43], 0 offen
Lfin2b:
    buffer_load_dwordx4 v[128:131], v2, s[28:31], s67 offen offset:0 nt
    s_waitcnt vmcnt(6)
    v_mfma_f32_16x16x32_bf16 v[28:31], v[140:143], v[52:55], v[28:31]
    buffer_load_dwordx4 v[132:135], v2, s[28:31], s67 offen offset:1024 nt
    s_nop 7
    v_mov_b32_dpp v10, v28 quad_perm:[0,0,0,0] row_mask:0xf bank_mask:0xf
    v_mov_b32_dpp v11, v29 quad_perm:[1,1,1,1] row_mask:0xf bank_mask:0xf
    v_mov_b32_dpp v12, v30 quad_perm:[2,2,2,2] row_mask:0xf bank_mask:0xf
    v_mov_b32_dpp v13, v31 quad_perm:[3,3,3,3] row_mask:0xf bank_mask:0xf
    v_add_f32 v10, v10, v11
    v_add_f32 v12, v12, v13
    v_add_f32 v10, v10, v12
    v_cvt_pk_bf16_f32 v10, v10, v10
    v_and_b32 v10, s76, v10
    v_mul_f32 v10, s77, v10
    v_cvt_pk_bf16_f32 v10, v10, v10
    v_and_b32 v10, s76, v10
    v_cmp_gt_f32 vcc, v10, v4
    s_nop 0
    s_cbranch_vccz Lnm3
    v_max_f32 v11, v10, v4
    s_nop 1
    v_max_f32_dpp v11, v11, v11 row_ror:4 row_mask:0xf bank_mask:0xf
    s_nop 1
    v_max_f32_dpp v11, v11, v11 row_ror:8 row_mask:0xf bank_mask:0xf
    v_mov_b32 v12, v11
    s_nop 1
    v_permlane16_swap_b32 v11, v12
    s_nop 0
    v_max_f32 v11, v11, v12
    v_mov_b32 v12, v11
    s_nop 1
    v_permlane32_swap_b32 v11, v12
    s_nop 0
    v_max_f32 v11, v11, v12
    v_sub_f32 v12, v4, v11
    v_mul_f32 v12, s78, v12
    v_exp_f32 v12, v12
    v_mov_b32 v4, v11
    v_mul_f32 v24, v24, v12
    v_mul_f32 v25, v25, v12
    v_mul_f32 v26, v26, v12
    v_mul_f32 v27, v27, v12
    v_mul_f32 v5, v5, v12
Lnm3:
    v_sub_f32 v10, v10, v4
    v_mul_f32 v10, s78, v10
    v_exp_f32 v10, v10
    s_nop 0
    v_cvt_pk_bf16_f32 v11, v10, v10
    v_add_f32 v5, v5, v10
    s_nop 0
    v_and_b32_dpp v32, v11, v20 row_newbcast:0 row_mask:0xf bank_mask:0xf
    v_and_b32_dpp v33, v11, v21 row_newbcast:0 row_mask:0xf bank_mask:0xf
    v_and_b32_dpp v34, v11, v22 row_newbcast:0 row_mask:0xf bank_mask:0xf
    v_and_b32_dpp v35, v11, v23 row_newbcast:0 row_mask:0xf bank_mask:0xf
    s_waitcnt vmcnt(6)
    s_nop 0
    v_mfma_f32_16x16x32_bf16 v[24:27], v[144:147], v[32:35], v[24:27]
    buffer_load_dwordx4 v[136:139], v2, s[28:31], s67 offen offset:2048 nt
    v_and_b32_dpp v36, v11, v20 row_newbcast:4 row_mask:0xf bank_mask:0xf
    v_and_b32_dpp v37, v11, v21 row_newbcast:4 row_mask:0xf bank_mask:0xf
    v_and_b32_dpp v38, v11, v22 row_newbcast:4 row_mask:0xf bank_mask:0xf
    v_and_b32_dpp v39, v11, v23 row_newbcast:4 row_mask:0xf bank_mask:0xf
    s_waitcnt vmcnt(6)
    s_nop 0
    v_mfma_f32_16x16x32_bf16 v[24:27], v[148:151], v[36:39], v[24:27]
    buffer_load_dwordx4 v[140:143], v2, s[28:31], s67 offen offset:3072 nt
    v_and_b32_dpp v32, v11, v20 row_newbcast:8 row_mask:0xf bank_mask:0xf
    v_and_b32_dpp v33, v11, v21 row_newbcast:8 row_mask:0xf bank_mask:0xf
    v_and_b32_dpp v34, v11, v22 row_newbcast:8 row_mask:0xf bank_mask:0xf
    v_and_b32_dpp v35, v11, v23 row_newbcast:8 row_mask:0xf bank_mask:0xf
    s_waitcnt vmcnt(6)
    s_nop 0
    v_mfma_f32_16x16x32_bf16 v[24:27], v[152:155], v[32:35], v[24:27]
    buffer_load_dwordx4 v[144:147], v3, s[32:35], s67 offen offset:0 nt
    v_and_b32_dpp v36, v11, v20 row_newbcast:12 row_mask:0xf bank_mask:0xf
    v_and_b32_dpp v37, v11, v21 row_newbcast:12 row_mask:0xf bank_mask:0xf
    v_and_b32_dpp v38, v11, v22 row_newbcast:12 row_mask:0xf bank_mask:0xf
    v_and_b32_dpp v39, v11, v23 row_newbcast:12 row_mask:0xf bank_mask:0xf
    s_waitcnt vmcnt(6)
    s_nop 0
    v_mfma_f32_16x16x32_bf16 v[24:27], v[156:159], v[36:39], v[24:27]
    buffer_load_dwordx4 v[148:151], v3, s[32:35], s67 offen offset:1024 nt
    s_cmp_lt_u32 s68, 96
    s_cbranch_scc1 Lloopb
    s_branch Lexitb
Lnewb:
    v_readfirstlane_b32 s68, v118
    s_cmp_lt_u32 s68, 96
    s_cbranch_scc0 Lfinb
    v_mov_b32 v118, 1
    buffer_atomic_add v118, v119, s[40:43], 0 offen sc0 sc1
    s_lshr_b32 s69, s68, 5
    s_min_u32 s69, s69, 1
    s_mul_i32 s69, s69, 1888
    s_add_u32 s69, s69, s68
    s_add_u32 s69, s69, 64
    s_lshl_b32 s67, s69, 12
    s_cmp_lt_u32 s68, 32
    s_cselect_b32 s86, 29, 0
    s_branch Lfin2b
Lfinb:
    v_and_b32 v14, 31, v1
    v_lshlrev_b32 v14, 2, v14
    buffer_load_dword v120, v14, s[56:59], 0 offen offset:128 sc1
    s_mov_b32 s67, 0x800000
    s_branch Lfin2b
Lexitb:
Lexita:
    s_waitcnt vmcnt(5)
LA:
    s_nop 1
    v_add_f32_dpp v5, v5, v5 row_ror:4 row_mask:0xf bank_mask:0xf
    s_nop 1
    v_add_f32_dpp v5, v5, v5 row_ror:8 row_mask:0xf bank_mask:0xf
    v_mov_b32 v10, v5
    s_nop 1
    v_permlane16_swap_b32 v5, v10
    s_nop 0
    v_add_f32 v5, v5, v10
    v_mov_b32 v10, v5
    s_nop 1
    v_permlane32_swap_b32 v5, v10
    s_nop 0
    v_add_f32 v5, v5, v10
    ds_write_b32 v19, v24 offset:4608
    ds_write_b32 v19, v25 offset:4640
    ds_write_b32 v19, v26 offset:4672
    ds_write_b32 v19, v27 offset:4704
    s_lshl_b32 s69, s63, 3
    v_mov_b32 v10, s69
    ds_write_b64 v10, v[4:5] offset:6656
    v_and_b32 v11, 31, v1
    v_lshlrev_b32 v11, 4, v11
    v_mov_b32 v10, 0
    s_waitcnt lgkmcnt(0)
    s_barrier
    s_cmp_lg_u32 s63, 0
    s_cbranch_scc1 LA2
    ds_read_b128 v[56:59], v10 offset:6656
    ds_read_b128 v[60:63], v10 offset:6672
    ds_read_b128 v[64:67], v11 offset:4608
    ds_read_b128 v[68:71], v11 offset:5120
    ds_read_b128 v[72:75], v11 offset:5632
    ds_read_b128 v[76:79], v11 offset:6144
    s_waitcnt lgkmcnt(4)
    v_max3_f32 v4, v56, v58, v60
    v_max_f32 v4, v4, v62
    v_sub_f32 v56, v56, v4
    v_sub_f32 v58, v58, v4
    v_sub_f32 v60, v60, v4
    v_sub_f32 v62, v62, v4
    v_mul_f32 v56, s78, v56
    v_mul_f32 v58, s78, v58
    v_mul_f32 v60, s78, v60
    v_mul_f32 v62, s78, v62
    v_exp_f32 v56, v56
    v_exp_f32 v58, v58
    v_exp_f32 v60, v60
    v_exp_f32 v62, v62
    v_cmp_le_u32 vcc, 32, v1
    v_mul_f32 v5, v56, v57
    v_fmac_f32 v5, v58, v59
    v_fmac_f32 v5, v60, v61
    v_fmac_f32 v5, v62, v63
    s_waitcnt lgkmcnt(0)
    v_mul_f32 v28, v56, v64
    v_mul_f32 v29, v56, v65
    v_mul_f32 v30, v56, v66
    v_mul_f32 v31, v56, v67
    v_fmac_f32 v28, v58, v68
    v_fmac_f32 v29, v58, v69
    v_fmac_f32 v30, v58, v70
    v_fmac_f32 v31, v58, v71
    v_fmac_f32 v28, v60, v72
    v_fmac_f32 v29, v60, v73
    v_fmac_f32 v30, v60, v74
    v_fmac_f32 v31, v60, v75
    v_fmac_f32 v28, v62, v76
    v_fmac_f32 v29, v62, v77
    v_fmac_f32 v30, v62, v78
    v_fmac_f32 v31, v62, v79
    v_cndmask_b32 v28, v28, v4, vcc
    v_cndmask_b32 v29, v29, v5, vcc
    v_cndmask_b32 v30, v30, v4, vcc
    v_cndmask_b32 v31, v31, v5, vcc
    v_min_u32 v28, -2, v28
    v_min_u32 v29, -2, v29
    v_min_u32 v30, -2, v30
    v_min_u32 v31, -2, v31
    buffer_store_dwordx4 v[28:31], v6, s[40:43], 0 offen sc1
LA2:
    s_cmp_lg_u32 s64, 1
    s_cbranch_scc1 Llt1b
    s_mov_b32 s69, 9216
    s_mov_b32 s70, 15*9216
    global_load_dwordx4 a[24:27], v[8:9], off nt
    v_add_co_u32 v8, s[74:75], s69, v8
    s_nop 1
    v_addc_co_u32 v9, s[74:75], 0, v9, s[74:75]
    global_load_dwordx4 a[28:31], v[8:9], off nt
    v_add_co_u32 v8, s[74:75], s70, v8
    s_nop 1
    v_addc_co_u32 v9, s[74:75], 0, v9, s[74:75]
    global_load_dwordx4 a[32:35], v[8:9], off nt
    v_add_co_u32 v8, s[74:75], s69, v8
    s_nop 1
    v_addc_co_u32 v9, s[74:75], 0, v9, s[74:75]
    global_load_dwordx4 a[36:39], v[8:9], off nt
    v_add_co_u32 v8, s[74:75], s70, v8
    s_nop 1
    v_addc_co_u32 v9, s[74:75], 0, v9, s[74:75]
    s_waitcnt vmcnt(3)
    global_load_dwordx4 a[40:43], v[8:9], off nt
    v_add_co_u32 v8, s[74:75], s69, v8
    s_nop 1
    v_addc_co_u32 v9, s[74:75], 0, v9, s[74:75]
    s_waitcnt vmcnt(3)
    global_load_dwordx4 a[44:47], v[8:9], off nt
    v_add_co_u32 v8, s[74:75], s70, v8
    s_nop 1
    v_addc_co_u32 v9, s[74:75], 0, v9, s[74:75]
    s_waitcnt vmcnt(3)
    global_load_dwordx4 a[48:51], v[8:9], off nt
    v_add_co_u32 v8, s[74:75], s69, v8
    s_nop 1
    v_addc_co_u32 v9, s[74:75], 0, v9, s[74:75]
    s_waitcnt vmcnt(3)
    global_load_dwordx4 a[52:55], v[8:9], off nt
    v_add_co_u32 v8, s[74:75], s70, v8
    s_nop 1
    v_addc_co_u32 v9, s[74:75], 0, v9, s[74:75]
    s_waitcnt vmcnt(3)
    global_load_dwordx4 a[56:59], v[8:9], off nt
    v_add_co_u32 v8, s[74:75], s69, v8
    s_nop 1
    v_addc_co_u32 v9, s[74:75], 0, v9, s[74:75]
    s_waitcnt vmcnt(3)
    global_load_dwordx4 a[60:63], v[8:9], off nt
    v_add_co_u32 v8, s[74:75], s70, v8
    s_nop 1
    v_addc_co_u32 v9, s[74:75], 0, v9, s[74:75]
    s_waitcnt vmcnt(3)
    global_load_dwordx4 a[64:67], v[8:9], off nt
    v_add_co_u32 v8, s[74:75], s69, v8
    s_nop 1
    v_addc_co_u32 v9, s[74:75], 0, v9, s[74:75]
    s_waitcnt vmcnt(3)
    global_load_dwordx4 a[68:71], v[8:9], off nt
    s_branch Llt2b
Llt1b:
Llt2b:
LA3:
    s_cmp_eq_u32 s64, 3
    s_cbranch_scc1 Lend
    v_lshrrev_b32 v15, 3, v1
    v_and_b32 v16, 7, v1
    s_cmp_lg_u32 s64, 1
    s_cbranch_scc1 LlN
    s_mul_i32 s69, s63, 288
    v_lshl_add_u32 v121, v1, 3, s69
    s_branch LlM
LlN:
    s_lshl_b32 s69, s65, 5
    v_and_b32 v121, 3, v1
    v_lshl_add_u32 v121, v121, 3, s69
LlM:
    buffer_load_dwordx2 v[122:123], v121, s[44:47], 0 offen
    v_bfe_u32 v17, v1, 4, 1
    v_lshl_add_u32 v17, v17, 5, v16
    v_and_b32 v19, 16, v1
    v_lshl_add_u32 v19, v16, 5, v19
    v_lshrrev_b32 v18, 5, v1
    s_lshl_b32 s69, s63, 1
    v_add_u32 v18, s69, v18
    s_mov_b32 s80, 0x00ff00ff
    s_mov_b32 s81, 0xff00ff00
Lfl:
    v_cmp_gt_u32 vcc, 8, v120
    s_nop 0
    s_cbranch_vccz Lfl2
    v_lshrrev_b32 v10, 2, v11
    buffer_load_dword v120, v10, s[56:59], 0 offen offset:128 sc1
    s_sub_u32 s71, s71, 1
    s_cbranch_scc1 Lend
    s_waitcnt vmcnt(0)
    s_branch Lfl
Lfl2:
    s_cmp_lg_u32 s64, 0
    s_cbranch_scc1 LC
    s_lshl_b32 s69, s63, 3
    s_add_u32 s69, s69, s66
    s_lshl_b32 s70, s69, 12
    v_lshl_add_u32 v12, v1, 4, s70
    s_lshl_b32 s70, s69, 7
    s_add_u32 s70, s70, 131072
    v_lshrrev_b32 v13, 5, v1
    v_lshl_add_u32 v13, v13, 4, s70
    v_lshl_add_u32 v124, v18, 8, v19
    s_lshl_b32 s69, s63, 9
    v_add_u32 v11, s69, v11
    v_lshl_add_u32 v14, v15, 4, s69
LpB1:
    buffer_load_dwordx2 v[56:57], v13, s[40:43], 0 offen offset:0 sc1
    buffer_load_dwordx2 v[58:59], v13, s[40:43], 0 offen offset:32 sc1
    buffer_load_dwordx2 v[60:61], v13, s[40:43], 0 offen offset:64 sc1
    buffer_load_dwordx2 v[62:63], v13, s[40:43], 0 offen offset:96 sc1
    buffer_load_dwordx4 v[64:67], v12, s[40:43], 0 offen offset:0 sc1
    buffer_load_dwordx4 v[68:71], v12, s[40:43], 0 offen offset:1024 sc1
    buffer_load_dwordx4 v[72:75], v12, s[40:43], 0 offen offset:2048 sc1
    buffer_load_dwordx4 v[76:79], v12, s[40:43], 0 offen offset:3072 sc1
    s_sub_u32 s71, s71, 1
    s_cbranch_scc1 Lend
    s_waitcnt vmcnt(0)
    v_max_u32 v10, v56, v57
    v_max3_u32 v10, v10, v58, v59
    v_max3_u32 v10, v10, v60, v61
    v_max3_u32 v10, v10, v62, v63
    v_max3_u32 v10, v10, v64, v65
    v_max3_u32 v10, v10, v66, v67
    v_max3_u32 v10, v10, v68, v69
    v_max3_u32 v10, v10, v70, v71
    v_max3_u32 v10, v10, v72, v73
    v_max3_u32 v10, v10, v74, v75
    v_max3_u32 v10, v10, v76, v77
    v_max3_u32 v10, v10, v78, v79
    v_cmp_eq_u32 vcc, -1, v10
    s_nop 0
    s_cbranch_vccnz LpB1
    v_max3_f32 v4, v56, v58, v60
    v_max_f32 v4, v4, v62
    v_mov_b32 v10, v4
    s_nop 1
    v_permlane32_swap_b32 v4, v10
    s_nop 0
    v_max_f32 v4, v4, v10
    v_sub_f32 v56, v56, v4
    v_sub_f32 v58, v58, v4
    v_sub_f32 v60, v60, v4
    v_sub_f32 v62, v62, v4
    v_mul_f32 v56, s78, v56
    v_mul_f32 v58, s78, v58
    v_mul_f32 v60, s78, v60
    v_mul_f32 v62, s78, v62
    v_exp_f32 v56, v56
    v_exp_f32 v58, v58
    v_exp_f32 v60, v60
    v_exp_f32 v62, v62
    s_nop 0
    v_mul_f32 v5, v56, v57
    v_fmac_f32 v5, v58, v59
    v_fmac_f32 v5, v60, v61
    v_fmac_f32 v5, v62, v63
    v_mul_f32 v28, v56, v64
    v_mul_f32 v29, v56, v65
    v_mul_f32 v30, v56, v66
    v_mul_f32 v31, v56, v67
    v_fmac_f32 v28, v58, v68
    v_fmac_f32 v29, v58, v69
    v_fmac_f32 v30, v58, v70
    v_fmac_f32 v31, v58, v71
    v_fmac_f32 v28, v60, v72
    v_fmac_f32 v29, v60, v73
    v_fmac_f32 v30, v60, v74
    v_fmac_f32 v31, v60, v75
    v_fmac_f32 v28, v62, v76
    v_fmac_f32 v29, v62, v77
    v_fmac_f32 v30, v62, v78
    v_fmac_f32 v31, v62, v79
    v_mov_b32 v56, v5
    v_mov_b32 v57, v28
    v_mov_b32 v58, v29
    v_mov_b32 v59, v30
    v_mov_b32 v60, v31
    s_nop 0
    v_permlane32_swap_b32 v5, v56
    v_permlane32_swap_b32 v28, v57
    v_permlane32_swap_b32 v29, v58
    v_permlane32_swap_b32 v30, v59
    v_permlane32_swap_b32 v31, v60
    v_add_f32 v5, v5, v56
    v_add_f32 v28, v28, v57
    v_add_f32 v29, v29, v58
    v_add_f32 v30, v30, v59
    v_add_f32 v31, v31, v60
    v_rcp_f32 v5, v5
    s_nop 0
    v_mul_f32 v28, v28, v5
    v_mul_f32 v29, v29, v5
    v_mul_f32 v30, v30, v5
    v_mul_f32 v31, v31, v5
    v_cvt_pk_bf16_f32 v28, v28, v28
    v_cvt_pk_bf16_f32 v29, v29, v29
    v_cvt_pk_bf16_f32 v30, v30, v30
    v_cvt_pk_bf16_f32 v31, v31, v31
    ds_write_b128 v11, v[28:31] offset:6912
    s_waitcnt lgkmcnt(0)
    ds_read_b128 v[56:59], v14 offset:6912
    ds_read_b128 v[60:63], v14 offset:7040
    ds_read_b128 v[64:67], v14 offset:7168
    ds_read_b128 v[68:71], v14 offset:7296
    s_waitcnt lgkmcnt(3)
    v_and_b32 v32, v56, v20
    v_and_b32 v33, v56, v21
    v_and_b32 v34, v56, v22
    v_and_b32 v35, v56, v23
    v_and_b32 v36, v57, v20
    v_and_b32 v37, v57, v21
    v_and_b32 v38, v57, v22
    v_and_b32 v39, v57, v23
    v_mfma_f32_16x16x32_bf16 v[24:27], v[32:35], a[0:3], 0
    v_and_b32 v32, v58, v20
    v_and_b32 v33, v58, v21
    v_and_b32 v34, v58, v22
    v_and_b32 v35, v58, v23
    v_mfma_f32_16x16x32_bf16 v[24:27], v[36:39], a[4:7], v[24:27]
    v_and_b32 v36, v59, v20
    v_and_b32 v37, v59, v21
    v_and_b32 v38, v59, v22
    v_and_b32 v39, v59, v23
    v_mfma_f32_16x16x32_bf16 v[24:27], v[32:35], a[8:11], v[24:27]
    s_waitcnt lgkmcnt(2)
    v_and_b32 v32, v60, v20
    v_and_b32 v33, v60, v21
    v_and_b32 v34, v60, v22
    v_and_b32 v35, v60, v23
    v_mfma_f32_16x16x32_bf16 v[24:27], v[36:39], a[12:15], v[24:27]
    v_and_b32 v36, v61, v20
    v_and_b32 v37, v61, v21
    v_and_b32 v38, v61, v22
    v_and_b32 v39, v61, v23
    v_mfma_f32_16x16x32_bf16 v[24:27], v[32:35], a[16:19], v[24:27]
    v_and_b32 v32, v62, v20
    v_and_b32 v33, v62, v21
    v_and_b32 v34, v62, v22
    v_and_b32 v35, v62, v23
    v_mfma_f32_16x16x32_bf16 v[24:27], v[36:39], a[20:23], v[24:27]
    v_and_b32 v36, v63, v20
    v_and_b32 v37, v63, v21
    v_and_b32 v38, v63, v22
    v_and_b32 v39, v63, v23
    v_mfma_f32_16x16x32_bf16 v[24:27], v[32:35], a[24:27], v[24:27]
    s_waitcnt lgkmcnt(1)
    v_and_b32 v32, v64, v20
    v_and_b32 v33, v64, v21
    v_and_b32 v34, v64, v22
    v_and_b32 v35, v64, v23
    v_mfma_f32_16x16x32_bf16 v[24:27], v[36:39], a[28:31], v[24:27]
    v_and_b32 v36, v65, v20
    v_and_b32 v37, v65, v21
    v_and_b32 v38, v65, v22
    v_and_b32 v39, v65, v23
    v_mfma_f32_16x16x32_bf16 v[24:27], v[32:35], a[32:35], v[24:27]
    v_and_b32 v32, v66, v20
    v_and_b32 v33, v66, v21
    v_and_b32 v34, v66, v22
    v_and_b32 v35, v66, v23
    v_mfma_f32_16x16x32_bf16 v[24:27], v[36:39], a[36:39], v[24:27]
    v_and_b32 v36, v67, v20
    v_and_b32 v37, v67, v21
    v_and_b32 v38, v67, v22
    v_and_b32 v39, v67, v23
    v_mfma_f32_16x16x32_bf16 v[24:27], v[32:35], a[40:43], v[24:27]
    s_waitcnt lgkmcnt(0)
    v_and_b32 v32, v68, v20
    v_and_b32 v33, v68, v21
    v_and_b32 v34, v68, v22
    v_and_b32 v35, v68, v23
    v_mfma_f32_16x16x32_bf16 v[24:27], v[36:39], a[44:47], v[24:27]
    v_and_b32 v36, v69, v20
    v_and_b32 v37, v69, v21
    v_and_b32 v38, v69, v22
    v_and_b32 v39, v69, v23
    v_mfma_f32_16x16x32_bf16 v[24:27], v[32:35], a[48:51], v[24:27]
    v_and_b32 v32, v70, v20
    v_and_b32 v33, v70, v21
    v_and_b32 v34, v70, v22
    v_and_b32 v35, v70, v23
    v_mfma_f32_16x16x32_bf16 v[24:27], v[36:39], a[52:55], v[24:27]
    v_and_b32 v36, v71, v20
    v_and_b32 v37, v71, v21
    v_and_b32 v38, v71, v22
    v_and_b32 v39, v71, v23
    v_mfma_f32_16x16x32_bf16 v[24:27], v[32:35], a[56:59], v[24:27]
    s_nop 1
    v_mfma_f32_16x16x32_bf16 v[24:27], v[36:39], a[60:63], v[24:27]
    v_lshlrev_b32 v10, 4, v1
    s_mov_b64 exec, s[80:81]
    s_nop 6
    ds_write_b128 v124, v[24:27] offset:8960
    s_waitcnt lgkmcnt(0)
    s_barrier
    s_cmp_lg_u32 s63, 0
    s_cbranch_scc1 Lend
    s_bfm_b64 exec, 16, 0
    ds_read_b128 v[56:59], v10 offset:8960
    ds_read_b128 v[60:63], v10 offset:9216
    ds_read_b128 v[64:67], v10 offset:9472
    ds_read_b128 v[68:71], v10 offset:9728
    ds_read_b128 v[72:75], v10 offset:9984
    ds_read_b128 v[76:79], v10 offset:10240
    ds_read_b128 v[80:83], v10 offset:10496
    ds_read_b128 v[84:87], v10 offset:10752
    s_waitcnt lgkmcnt(6)
    v_pk_add_f32 v[56:57], v[56:57], v[60:61]
    v_pk_add_f32 v[58:59], v[58:59], v[62:63]
    s_waitcnt lgkmcnt(4)
    v_pk_add_f32 v[64:65], v[64:65], v[68:69]
    v_pk_add_f32 v[66:67], v[66:67], v[70:71]
    v_pk_add_f32 v[56:57], v[56:57], v[64:65]
    v_pk_add_f32 v[58:59], v[58:59], v[66:67]
    s_waitcnt lgkmcnt(2)
    v_pk_add_f32 v[72:73], v[72:73], v[76:77]
    v_pk_add_f32 v[74:75], v[74:75], v[78:79]
    s_waitcnt lgkmcnt(0)
    v_pk_add_f32 v[80:81], v[80:81], v[84:85]
    v_pk_add_f32 v[82:83], v[82:83], v[86:87]
    v_pk_add_f32 v[72:73], v[72:73], v[80:81]
    v_pk_add_f32 v[74:75], v[74:75], v[82:83]
    v_pk_add_f32 v[56:57], v[56:57], v[72:73]
    v_pk_add_f32 v[58:59], v[58:59], v[74:75]
    v_min_u32 v56, -2, v56
    v_min_u32 v57, -2, v57
    v_min_u32 v58, -2, v58
    v_min_u32 v59, -2, v59
    buffer_store_dwordx4 v[56:59], v7, s[40:43], 0 offen sc1
    s_branch Lend
LC:
    s_cmp_eq_u32 s64, 1
    s_cbranch_scc1 LC1
    s_cmp_lg_u32 s63, 0
    s_cbranch_scc1 Lend
LC1:
    v_lshlrev_b32 v12, 1, v121
    v_add_u32 v13, 135168, v12
    s_mul_i32 s69, s66, 2304
    s_mov_b32 s82, 4608
    s_mov_b32 s83, 9216
    s_mov_b32 s84, 13824
    v_mov_b32 v96, 0
    v_mov_b32 v97, 0
    s_lshl_b32 s70, s63, 9
    v_lshl_add_u32 v98, v1, 3, s70
    v_lshlrev_b32 v124, 5, v17
    v_lshl_add_u32 v124, v18, 2, v124
    v_mul_u32_u24 v120, 2304, v18
    v_add_u32 v120, v19, v120
    s_mul_i32 s70, s63, 576
    v_lshl_add_u32 v99, v15, 3, s70
    s_lshl_b32 s70, s63, 8
    v_lshl_add_u32 v100, v15, 5, s70
    v_mov_b32 v14, 11768
    s_and_b32 s87, s64, 1
    s_bfm_b64 exec, 1, 0
    buffer_load_dword v56, v13, s[40:43], s69 offen sc1
    s_waitcnt vmcnt(0)
    v_cmp_eq_u32 vcc, -1, v56
    s_mov_b64 exec, -1
    v_lshlrev_b32 v28, 16, v122
    v_and_b32 v29, s76, v122
    v_lshlrev_b32 v30, 16, v123
    v_and_b32 v31, s76, v123
    s_cbranch_vccz LCg
    s_cmp_eq_u32 s87, 0
    s_cbranch_scc1 LCf
    buffer_load_dwordx4 a[72:75], v117, s[36:39], 0 offen offset:0 nt
    buffer_load_dwordx4 a[76:79], v117, s[36:39], 0 offen offset:128 nt
    buffer_load_dwordx4 a[80:83], v117, s[36:39], 0 offen offset:256 nt
    buffer_load_dwordx4 a[84:87], v117, s[36:39], 0 offen offset:384 nt
    buffer_load_dwordx4 a[88:91], v117, s[36:39], 0 offen offset:512 nt
    buffer_load_dwordx4 a[92:95], v117, s[36:39], 0 offen offset:640 nt
    buffer_load_dwordx4 a[96:99], v117, s[36:39], 0 offen offset:768 nt
    buffer_load_dwordx4 a[100:103], v117, s[36:39], 0 offen offset:896 nt
    buffer_load_dwordx4 a[104:107], v117, s[36:39], 0 offen offset:1024 nt
    s_mov_b32 s87, 0
LCf:
    s_bfm_b64 exec, 1, 0
LpC0:
    buffer_load_dword v56, v13, s[40:43], s69 offen sc1
    s_sub_u32 s71, s71, 1
    s_cbranch_scc1 Lend
    s_waitcnt vmcnt(0)
    v_max_u32 v10, v56, v56
    v_cmp_eq_u32 vcc, -1, v10
    s_nop 0
    s_cbranch_vccnz LpC0
LCg:
    s_bfm_b64 exec, 36, 0
LpC1:
    buffer_load_dwordx4 v[56:59], v13, s[40:43], 0 offen offset:0 sc1
    buffer_load_dwordx4 v[60:63], v13, s[40:43], 0 offen offset:2304 sc1
    buffer_load_dwordx4 v[64:67], v13, s[40:43], s82 offen offset:0 sc1
    buffer_load_dwordx4 v[68:71], v13, s[40:43], s82 offen offset:2304 sc1
    buffer_load_dwordx4 v[72:75], v13, s[40:43], s83 offen offset:0 sc1
    buffer_load_dwordx4 v[76:79], v13, s[40:43], s83 offen offset:2304 sc1
    buffer_load_dwordx4 v[80:83], v13, s[40:43], s84 offen offset:0 sc1
    buffer_load_dwordx4 v[84:87], v13, s[40:43], s84 offen offset:2304 sc1
    s_sub_u32 s71, s71, 1
    s_cbranch_scc1 Lend
    s_cmp_eq_u32 s87, 0
    s_cbranch_scc1 LCh
    s_mov_b64 exec, -1
    buffer_load_dwordx4 a[72:75], v117, s[36:39], 0 offen offset:0 nt
    buffer_load_dwordx4 a[76:79], v117, s[36:39], 0 offen offset:128 nt
    buffer_load_dwordx4 a[80:83], v117, s[36:39], 0 offen offset:256 nt
    buffer_load_dwordx4 a[84:87], v117, s[36:39], 0 offen offset:384 nt
    buffer_load_dwordx4 a[88:91], v117, s[36:39], 0 offen offset:512 nt
    buffer_load_dwordx4 a[92:95], v117, s[36:39], 0 offen offset:640 nt
    buffer_load_dwordx4 a[96:99], v117, s[36:39], 0 offen offset:768 nt
    buffer_load_dwordx4 a[100:103], v117, s[36:39], 0 offen offset:896 nt
    buffer_load_dwordx4 a[104:107], v117, s[36:39], 0 offen offset:1024 nt
    s_bfm_b64 exec, 36, 0
    s_mov_b32 s87, 0
    s_waitcnt vmcnt(9)
    s_branch LCi
LCh:
    s_waitcnt vmcnt(0)
LCi:
    v_max_u32 v10, v56, v57
    v_max3_u32 v10, v10, v58, v59
    v_max3_u32 v10, v10, v60, v61
    v_max3_u32 v10, v10, v62, v63
    v_max3_u32 v10, v10, v64, v65
    v_max3_u32 v10, v10, v66, v67
    v_max3_u32 v10, v10, v68, v69
    v_max3_u32 v10, v10, v70, v71
    v_max3_u32 v10, v10, v72, v73
    v_max3_u32 v10, v10, v74, v75
    v_max3_u32 v10, v10, v76, v77
    v_max3_u32 v10, v10, v78, v79
    v_max3_u32 v10, v10, v80, v81
    v_max3_u32 v10, v10, v82, v83
    v_max3_u32 v10, v10, v84, v85
    v_max3_u32 v10, v10, v86, v87
    v_cmp_eq_u32 vcc, -1, v10
    s_nop 0
    s_cbranch_vccnz LpC1
    v_pk_add_f32 v[56:57], v[56:57], v[72:73]
    v_pk_add_f32 v[58:59], v[58:59], v[74:75]
    v_pk_add_f32 v[60:61], v[60:61], v[76:77]
    v_pk_add_f32 v[62:63], v[62:63], v[78:79]
    v_pk_add_f32 v[64:65], v[64:65], v[80:81]
    v_pk_add_f32 v[66:67], v[66:67], v[82:83]
    v_pk_add_f32 v[68:69], v[68:69], v[84:85]
    v_pk_add_f32 v[70:71], v[70:71], v[86:87]
    v_pk_add_f32 v[56:57], v[56:57], v[64:65]
    v_pk_add_f32 v[58:59], v[58:59], v[66:67]
    v_pk_add_f32 v[60:61], v[60:61], v[68:69]
    v_pk_add_f32 v[62:63], v[62:63], v[70:71]
    v_pk_add_f32 v[56:57], v[56:57], v[60:61]
    v_pk_add_f32 v[58:59], v[58:59], v[62:63]
    v_cvt_pk_bf16_f32 v60, v56, v57
    v_cvt_pk_bf16_f32 v61, v58, v59
    v_lshlrev_b32 v56, 16, v60
    v_and_b32 v57, s76, v60
    v_lshlrev_b32 v58, 16, v61
    v_and_b32 v59, s76, v61
    v_pk_add_f32 v[28:29], v[28:29], v[56:57]
    v_pk_add_f32 v[30:31], v[30:31], v[58:59]
    v_cvt_pk_bf16_f32 v60, v28, v29
    v_cvt_pk_bf16_f32 v61, v30, v31
    v_lshlrev_b32 v28, 16, v60
    v_and_b32 v29, s76, v60
    v_lshlrev_b32 v30, 16, v61
    v_and_b32 v31, s76, v61
    s_cmp_lg_u32 s64, 1
    s_cbranch_scc1 LE
    v_readfirstlane_b32 s69, v28
    s_nop 1
    v_subrev_f32 v56, s69, v28
    v_subrev_f32 v57, s69, v29
    v_subrev_f32 v58, s69, v30
    v_subrev_f32 v59, s69, v31
    v_mul_f32 v97, v56, v56
    v_add_f32 v96, v56, v57
    v_fmac_f32 v97, v57, v57
    v_add_f32 v96, v96, v58
    v_fmac_f32 v97, v58, v58
    v_add_f32 v96, v96, v59
    v_fmac_f32 v97, v59, v59
    s_mov_b64 exec, -1
    s_nop 0
    v_add_f32_dpp v96, v96, v96 row_ror:1 row_mask:0xf bank_mask:0xf
    v_add_f32_dpp v97, v97, v97 row_ror:1 row_mask:0xf bank_mask:0xf
    s_nop 0
    v_add_f32_dpp v96, v96, v96 row_ror:2 row_mask:0xf bank_mask:0xf
    v_add_f32_dpp v97, v97, v97 row_ror:2 row_mask:0xf bank_mask:0xf
    s_nop 0
    v_add_f32_dpp v96, v96, v96 row_ror:4 row_mask:0xf bank_mask:0xf
    v_add_f32_dpp v97, v97, v97 row_ror:4 row_mask:0xf bank_mask:0xf
    s_nop 0
    v_add_f32_dpp v96, v96, v96 row_ror:8 row_mask:0xf bank_mask:0xf
    v_add_f32_dpp v97, v97, v97 row_ror:8 row_mask:0xf bank_mask:0xf
    s_nop 0
    v_add_f32_dpp v96, v96, v96 row_bcast:15 row_mask:0xa bank_mask:0xf
    v_add_f32_dpp v97, v97, v97 row_bcast:15 row_mask:0xa bank_mask:0xf
    s_nop 0
    v_add_f32_dpp v96, v96, v96 row_bcast:31 row_mask:0xc bank_mask:0xf
    v_add_f32_dpp v97, v97, v97 row_bcast:31 row_mask:0xc bank_mask:0xf
    v_mul_f32 v56, 0x3be38e39, v96
    v_fma_f32 v97, -v56, v96, v97
    v_add_f32 v96, s69, v56
    ds_write_b64 v98, v[96:97] offset:11264
    s_waitcnt lgkmcnt(0)
    s_barrier
    ds_read2st64_b64 v[56:59], v14 offset0:0 offset1:1
    ds_read2st64_b64 v[60:63], v14 offset0:2 offset1:3
    s_bfm_b64 exec, 36, 0
    s_mov_b32 s69, 0x3e800000
    s_waitcnt lgkmcnt(0)
    v_pk_add_f32 v[64:65], v[56:57], v[60:61]
    v_pk_add_f32 v[66:67], v[58:59], v[62:63]
    v_pk_add_f32 v[10:11], v[64:65], v[66:67]
    v_mul_f32 v10, s69, v10
    v_mul_f32 v11, 0x3be38e39, v11
    v_sub_f32 v56, v56, v10
    v_sub_f32 v58, v58, v10
    v_sub_f32 v60, v60, v10
    v_sub_f32 v62, v62, v10
    v_fmac_f32 v11, v56, v56
    v_fmac_f32 v11, v58, v58
    v_fmac_f32 v11, v60, v60
    v_fmac_f32 v11, v62, v62
    v_mul_f32 v11, s69, v11
    v_cvt_pk_bf16_f32 v11, v11, v11
    v_and_b32 v11, s76, v11
    v_add_f32 v11, 0x3727c5ac, v11
    v_cvt_pk_bf16_f32 v11, v11, v11
    v_and_b32 v11, s76, v11
    v_sqrt_f32 v11, v11
    v_cvt_pk_bf16_f32 v10, v10, v10
    v_and_b32 v10, s76, v10
    v_sub_f32 v28, v28, v10
    v_sub_f32 v29, v29, v10
    v_sub_f32 v30, v30, v10
    v_sub_f32 v31, v31, v10
    v_cvt_pk_bf16_f32 v11, v11, v11
    v_and_b32 v11, s76, v11
    v_rcp_f32 v13, v11
    v_cvt_pk_bf16_f32 v60, v28, v29
    v_cvt_pk_bf16_f32 v61, v30, v31
    v_lshlrev_b32 v28, 16, v60
    v_and_b32 v29, s76, v60
    v_lshlrev_b32 v30, 16, v61
    v_and_b32 v31, s76, v61
    v_mul_f32 v56, v28, v13
    v_mul_f32 v57, v29, v13
    v_mul_f32 v58, v30, v13
    v_mul_f32 v59, v31, v13
    v_fma_f32 v28, -v56, v11, v28
    v_fma_f32 v29, -v57, v11, v29
    v_fma_f32 v30, -v58, v11, v30
    v_fma_f32 v31, -v59, v11, v31
    v_fmac_f32 v56, v28, v13
    v_fmac_f32 v57, v29, v13
    v_fmac_f32 v58, v30, v13
    v_fmac_f32 v59, v31, v13
    v_cvt_pk_bf16_f32 v56, v56, v56
    v_cvt_pk_bf16_f32 v57, v57, v57
    v_cvt_pk_bf16_f32 v58, v58, v58
    v_cvt_pk_bf16_f32 v59, v59, v59
    ds_write_b128 v12, v[56:59] offset:0
    s_mov_b64 exec, -1
    ds_read_b64 v[56:57], v99 offset:0
    ds_read_b64 v[58:59], v99 offset:64
    ds_read_b64 v[60:61], v99 offset:128
    ds_read_b64 v[62:63], v99 offset:192
    ds_read_b64 v[64:65], v99 offset:256
    ds_read_b64 v[66:67], v99 offset:320
    ds_read_b64 v[68:69], v99 offset:384
    ds_read_b64 v[70:71], v99 offset:448
    ds_read_b64 v[72:73], v99 offset:512
    s_waitcnt lgkmcnt(8)
    v_and_b32 v32, v56, v20
    v_and_b32 v33, v56, v21
    v_and_b32 v34, v56, v22
    v_and_b32 v35, v56, v23
    v_and_b32 v36, v57, v20
    v_and_b32 v37, v57, v21
    v_and_b32 v38, v57, v22
    v_and_b32 v39, v57, v23
    v_mfma_f32_16x16x32_bf16 v[24:27], a[0:3], v[32:35], 0
    s_waitcnt lgkmcnt(7)
    v_and_b32 v32, v58, v20
    v_and_b32 v33, v58, v21
    v_and_b32 v34, v58, v22
    v_and_b32 v35, v58, v23
    v_mfma_f32_16x16x32_bf16 v[24:27], a[4:7], v[36:39], v[24:27]
    v_and_b32 v36, v59, v20
    v_and_b32 v37, v59, v21
    v_and_b32 v38, v59, v22
    v_and_b32 v39, v59, v23
    v_mfma_f32_16x16x32_bf16 v[24:27], a[8:11], v[32:35], v[24:27]
    s_waitcnt lgkmcnt(6)
    v_and_b32 v32, v60, v20
    v_and_b32 v33, v60, v21
    v_and_b32 v34, v60, v22
    v_and_b32 v35, v60, v23
    v_mfma_f32_16x16x32_bf16 v[24:27], a[12:15], v[36:39], v[24:27]
    v_and_b32 v36, v61, v20
    v_and_b32 v37, v61, v21
    v_and_b32 v38, v61, v22
    v_and_b32 v39, v61, v23
    v_mfma_f32_16x16x32_bf16 v[24:27], a[16:19], v[32:35], v[24:27]
    s_waitcnt lgkmcnt(5)
    v_and_b32 v32, v62, v20
    v_and_b32 v33, v62, v21
    v_and_b32 v34, v62, v22
    v_and_b32 v35, v62, v23
    v_mfma_f32_16x16x32_bf16 v[24:27], a[20:23], v[36:39], v[24:27]
    v_and_b32 v36, v63, v20
    v_and_b32 v37, v63, v21
    v_and_b32 v38, v63, v22
    v_and_b32 v39, v63, v23
    v_mfma_f32_16x16x32_bf16 v[24:27], a[24:27], v[32:35], v[24:27]
    s_waitcnt lgkmcnt(4)
    v_and_b32 v32, v64, v20
    v_and_b32 v33, v64, v21
    v_and_b32 v34, v64, v22
    v_and_b32 v35, v64, v23
    v_mfma_f32_16x16x32_bf16 v[24:27], a[28:31], v[36:39], v[24:27]
    v_and_b32 v36, v65, v20
    v_and_b32 v37, v65, v21
    v_and_b32 v38, v65, v22
    v_and_b32 v39, v65, v23
    v_mfma_f32_16x16x32_bf16 v[24:27], a[32:35], v[32:35], v[24:27]
    s_waitcnt lgkmcnt(3)
    v_and_b32 v32, v66, v20
    v_and_b32 v33, v66, v21
    v_and_b32 v34, v66, v22
    v_and_b32 v35, v66, v23
    v_mfma_f32_16x16x32_bf16 v[24:27], a[36:39], v[36:39], v[24:27]
    v_and_b32 v36, v67, v20
    v_and_b32 v37, v67, v21
    v_and_b32 v38, v67, v22
    v_and_b32 v39, v67, v23
    v_mfma_f32_16x16x32_bf16 v[24:27], a[40:43], v[32:35], v[24:27]
    s_waitcnt lgkmcnt(2)
    v_and_b32 v32, v68, v20
    v_and_b32 v33, v68, v21
    v_and_b32 v34, v68, v22
    v_and_b32 v35, v68, v23
    v_mfma_f32_16x16x32_bf16 v[24:27], a[44:47], v[36:39], v[24:27]
    v_and_b32 v36, v69, v20
    v_and_b32 v37, v69, v21
    v_and_b32 v38, v69, v22
    v_and_b32 v39, v69, v23
    v_mfma_f32_16x16x32_bf16 v[24:27], a[48:51], v[32:35], v[24:27]
    s_waitcnt lgkmcnt(1)
    v_and_b32 v32, v70, v20
    v_and_b32 v33, v70, v21
    v_and_b32 v34, v70, v22
    v_and_b32 v35, v70, v23
    v_mfma_f32_16x16x32_bf16 v[24:27], a[52:55], v[36:39], v[24:27]
    v_and_b32 v36, v71, v20
    v_and_b32 v37, v71, v21
    v_and_b32 v38, v71, v22
    v_and_b32 v39, v71, v23
    v_mfma_f32_16x16x32_bf16 v[24:27], a[56:59], v[32:35], v[24:27]
    s_waitcnt lgkmcnt(0)
    v_and_b32 v32, v72, v20
    v_and_b32 v33, v72, v21
    v_and_b32 v34, v72, v22
    v_and_b32 v35, v72, v23
    v_mfma_f32_16x16x32_bf16 v[24:27], a[60:63], v[36:39], v[24:27]
    v_and_b32 v36, v73, v20
    v_and_b32 v37, v73, v21
    v_and_b32 v38, v73, v22
    v_and_b32 v39, v73, v23
    v_mfma_f32_16x16x32_bf16 v[24:27], a[64:67], v[32:35], v[24:27]
    s_nop 1
    v_mfma_f32_16x16x32_bf16 v[24:27], a[68:71], v[36:39], v[24:27]
    s_mov_b64 exec, s[80:81]
    s_nop 7
    ds_write_b32 v124, v24 offset:8960
    ds_write_b32 v124, v25 offset:9216
    ds_write_b32 v124, v26 offset:9472
    ds_write_b32 v124, v27 offset:9728
    s_mov_b64 exec, -1
    s_waitcnt lgkmcnt(0)
    s_barrier
    ds_read_b128 v[56:59], v100 offset:8960
    ds_read_b128 v[60:63], v100 offset:8976
    ds_read_b128 v[64:67], v100 offset:9984
    ds_read_b128 v[68:71], v100 offset:10000
    s_waitcnt lgkmcnt(2)
    v_pk_add_f32 v[56:57], v[56:57], v[60:61]
    v_pk_add_f32 v[58:59], v[58:59], v[62:63]
    s_waitcnt lgkmcnt(0)
    v_pk_add_f32 v[64:65], v[64:65], v[68:69]
    v_pk_add_f32 v[66:67], v[66:67], v[70:71]
    v_pk_add_f32 v[56:57], v[56:57], v[58:59]
    v_pk_add_f32 v[64:65], v[64:65], v[66:67]
    v_add_f32 v56, v56, v57
    v_add_f32 v64, v64, v65
    v_cvt_pk_bf16_f32 v56, v56, v64
    v_and_b32 v64, s76, v56
    v_lshlrev_b32 v56, 16, v56
    v_mul_f32 v56, v56, v64
    v_cvt_pk_bf16_f32 v56, v56, v56
    v_and_b32 v32, v56, v20
    v_and_b32 v33, v56, v21
    v_and_b32 v34, v56, v22
    v_and_b32 v35, v56, v23
    s_nop 0
    s_waitcnt vmcnt(0)
    v_mfma_f32_16x16x32_bf16 v[56:59], v[32:35], a[72:75], 0
    v_mfma_f32_16x16x32_bf16 v[60:63], v[32:35], a[76:79], 0
    v_mfma_f32_16x16x32_bf16 v[64:67], v[32:35], a[80:83], 0
    v_mfma_f32_16x16x32_bf16 v[68:71], v[32:35], a[84:87], 0
    v_mfma_f32_16x16x32_bf16 v[72:75], v[32:35], a[88:91], 0
    v_mfma_f32_16x16x32_bf16 v[76:79], v[32:35], a[92:95], 0
    v_mfma_f32_16x16x32_bf16 v[80:83], v[32:35], a[96:99], 0
    v_mfma_f32_16x16x32_bf16 v[84:87], v[32:35], a[100:103], 0
    v_mfma_f32_16x16x32_bf16 v[88:91], v[32:35], a[104:107], 0
    v_lshlrev_b32 v10, 1, v121
    s_mov_b64 exec, s[80:81]
    ds_write_b128 v120, v[56:59] offset:13568
    ds_write_b128 v120, v[60:63] offset:13824
    ds_write_b128 v120, v[64:67] offset:14080
    ds_write_b128 v120, v[68:71] offset:14336
    ds_write_b128 v120, v[72:75] offset:14592
    ds_write_b128 v120, v[76:79] offset:14848
    ds_write_b128 v120, v[80:83] offset:15104
    ds_write_b128 v120, v[84:87] offset:15360
    ds_write_b128 v120, v[88:91] offset:15616
    s_waitcnt lgkmcnt(0)
    s_barrier
    s_bfm_b64 exec, 36, 0
    ds_read_b128 v[56:59], v10 offset:13568
    ds_read_b128 v[60:63], v10 offset:15872
    ds_read_b128 v[64:67], v10 offset:18176
    ds_read_b128 v[68:71], v10 offset:20480
    ds_read_b128 v[72:75], v10 offset:22784
    ds_read_b128 v[76:79], v10 offset:25088
    ds_read_b128 v[80:83], v10 offset:27392
    ds_read_b128 v[84:87], v10 offset:29696
    s_waitcnt lgkmcnt(6)
    v_pk_add_f32 v[56:57], v[56:57], v[60:61]
    v_pk_add_f32 v[58:59], v[58:59], v[62:63]
    s_waitcnt lgkmcnt(4)
    v_pk_add_f32 v[64:65], v[64:65], v[68:69]
    v_pk_add_f32 v[66:67], v[66:67], v[70:71]
    v_pk_add_f32 v[56:57], v[56:57], v[64:65]
    v_pk_add_f32 v[58:59], v[58:59], v[66:67]
    s_waitcnt lgkmcnt(2)
    v_pk_add_f32 v[72:73], v[72:73], v[76:77]
    v_pk_add_f32 v[74:75], v[74:75], v[78:79]
    s_waitcnt lgkmcnt(0)
    v_pk_add_f32 v[80:81], v[80:81], v[84:85]
    v_pk_add_f32 v[82:83], v[82:83], v[86:87]
    v_pk_add_f32 v[72:73], v[72:73], v[80:81]
    v_pk_add_f32 v[74:75], v[74:75], v[82:83]
    v_pk_add_f32 v[56:57], v[56:57], v[72:73]
    v_pk_add_f32 v[58:59], v[58:59], v[74:75]
    v_min_u32 v56, -2, v56
    v_min_u32 v57, -2, v57
    v_min_u32 v58, -2, v58
    v_min_u32 v59, -2, v59
    buffer_store_dwordx4 v[56:59], v7, s[40:43], 0 offen sc1
    s_branch Lend
LE:
    s_mov_b64 exec, -1
    s_mul_i32 s69, s65, 9216
    s_add_u32 s69, s69, 163840
    v_lshl_add_u32 v12, v1, 4, s69
    s_mov_b32 s69, 4096
    s_mov_b32 s70, 8192
    s_mov_b32 s52, s22
    s_and_b32 s53, s23, 0xffff
    s_mov_b32 s54, 1152
    s_mov_b32 s55, 0x20000
LpE1:
    buffer_load_dwordx4 v[56:59], v12, s[40:43], 0 offen offset:0 sc1
    buffer_load_dwordx4 v[60:63], v12, s[40:43], 0 offen offset:1024 sc1
    buffer_load_dwordx4 v[64:67], v12, s[40:43], 0 offen offset:2048 sc1
    buffer_load_dwordx4 v[68:71], v12, s[40:43], 0 offen offset:3072 sc1
    buffer_load_dwordx4 v[72:75], v12, s[40:43], s69 offen offset:0 sc1
    buffer_load_dwordx4 v[76:79], v12, s[40:43], s69 offen offset:1024 sc1
    buffer_load_dwordx4 v[80:83], v12, s[40:43], s69 offen offset:2048 sc1
    buffer_load_dwordx4 v[84:87], v12, s[40:43], s69 offen offset:3072 sc1
    buffer_load_dwordx4 v[88:91], v12, s[40:43], s70 offen offset:0 sc1
    s_sub_u32 s71, s71, 1
    s_cbranch_scc1 Lend
    s_waitcnt vmcnt(0)
    v_max_u32 v10, v56, v57
    v_max3_u32 v10, v10, v58, v59
    v_max3_u32 v10, v10, v60, v61
    v_max3_u32 v10, v10, v62, v63
    v_max3_u32 v10, v10, v64, v65
    v_max3_u32 v10, v10, v66, v67
    v_max3_u32 v10, v10, v68, v69
    v_max3_u32 v10, v10, v70, v71
    v_max3_u32 v10, v10, v72, v73
    v_max3_u32 v10, v10, v74, v75
    v_max3_u32 v10, v10, v76, v77
    v_max3_u32 v10, v10, v78, v79
    v_max3_u32 v10, v10, v80, v81
    v_max3_u32 v10, v10, v82, v83
    v_max3_u32 v10, v10, v84, v85
    v_max3_u32 v10, v10, v86, v87
    v_max3_u32 v10, v10, v88, v89
    v_max3_u32 v10, v10, v90, v91
    v_cmp_eq_u32 vcc, -1, v10
    s_nop 0
    s_cbranch_vccnz LpE1
    v_pk_add_f32 v[56:57], v[56:57], v[88:89]
    v_pk_add_f32 v[58:59], v[58:59], v[90:91]
    v_pk_add_f32 v[56:57], v[56:57], v[72:73]
    v_pk_add_f32 v[58:59], v[58:59], v[74:75]
    v_pk_add_f32 v[60:61], v[60:61], v[76:77]
    v_pk_add_f32 v[62:63], v[62:63], v[78:79]
    v_pk_add_f32 v[64:65], v[64:65], v[80:81]
    v_pk_add_f32 v[66:67], v[66:67], v[82:83]
    v_pk_add_f32 v[68:69], v[68:69], v[84:85]
    v_pk_add_f32 v[70:71], v[70:71], v[86:87]
    v_pk_add_f32 v[56:57], v[56:57], v[64:65]
    v_pk_add_f32 v[58:59], v[58:59], v[66:67]
    v_pk_add_f32 v[60:61], v[60:61], v[68:69]
    v_pk_add_f32 v[62:63], v[62:63], v[70:71]
    v_pk_add_f32 v[56:57], v[56:57], v[60:61]
    v_pk_add_f32 v[58:59], v[58:59], v[62:63]
    s_nop 1
    v_add_f32_dpp v56, v56, v56 row_ror:4 row_mask:0xf bank_mask:0xf
    v_add_f32_dpp v57, v57, v57 row_ror:4 row_mask:0xf bank_mask:0xf
    v_add_f32_dpp v58, v58, v58 row_ror:4 row_mask:0xf bank_mask:0xf
    v_add_f32_dpp v59, v59, v59 row_ror:4 row_mask:0xf bank_mask:0xf
    v_add_f32_dpp v56, v56, v56 row_ror:8 row_mask:0xf bank_mask:0xf
    v_add_f32_dpp v57, v57, v57 row_ror:8 row_mask:0xf bank_mask:0xf
    v_add_f32_dpp v58, v58, v58 row_ror:8 row_mask:0xf bank_mask:0xf
    v_add_f32_dpp v59, v59, v59 row_ror:8 row_mask:0xf bank_mask:0xf
    v_mov_b32 v60, v56
    v_mov_b32 v61, v57
    v_mov_b32 v62, v58
    v_mov_b32 v63, v59
    v_permlane16_swap_b32 v56, v60
    v_permlane16_swap_b32 v57, v61
    v_permlane16_swap_b32 v58, v62
    v_permlane16_swap_b32 v59, v63
    v_add_f32 v56, v56, v60
    v_add_f32 v57, v57, v61
    v_add_f32 v58, v58, v62
    v_add_f32 v59, v59, v63
    v_mov_b32 v60, v56
    v_mov_b32 v61, v57
    v_mov_b32 v62, v58
    v_mov_b32 v63, v59
    v_permlane32_swap_b32 v56, v60
    v_permlane32_swap_b32 v57, v61
    v_permlane32_swap_b32 v58, v62
    v_permlane32_swap_b32 v59, v63
    v_add_f32 v56, v56, v60
    v_add_f32 v57, v57, v61
    v_add_f32 v58, v58, v62
    v_add_f32 v59, v59, v63
    v_cvt_pk_bf16_f32 v56, v56, v56
    v_and_b32 v56, s76, v56
    v_cvt_pk_bf16_f32 v57, v57, v57
    v_and_b32 v57, s76, v57
    v_cvt_pk_bf16_f32 v58, v58, v58
    v_and_b32 v58, s76, v58
    v_cvt_pk_bf16_f32 v59, v59, v59
    v_and_b32 v59, s76, v59
    v_add_f32 v56, v56, v28
    v_add_f32 v57, v57, v29
    v_add_f32 v58, v58, v30
    v_add_f32 v59, v59, v31
    v_cvt_pk_bf16_f32 v56, v56, v57
    v_cvt_pk_bf16_f32 v57, v58, v59
    s_bfm_b64 exec, 4, 0
    buffer_store_dwordx2 v[56:57], v121, s[52:55], 0 offen
Lend:
    s_endpgm
.section .rodata,"a"
.p2align 6
.amdhsa_kernel sequential_preLN__mha_block_cached__glu_gated_bilinear__decode_kernel
  .amdhsa_next_free_vgpr 512
  .amdhsa_next_free_sgpr 96
  .amdhsa_accum_offset 256
  .amdhsa_group_segment_fixed_size 0
  .amdhsa_kernarg_size 96
  .amdhsa_user_sgpr_count 2
  .amdhsa_user_sgpr_kernarg_segment_ptr 1
  .amdhsa_system_sgpr_workgroup_id_x 1
.end_amdhsa_kernel
```
